```python
import torch

def _softmax(x, axis=-1):
    return torch.softmax(x, dim=axis)
def _gelu(x):
    return torch.nn.functional.gelu(x, approximate="tanh")
def _silu(x):
    return torch.nn.functional.silu(x)
def _sigmoid(x):
    return torch.sigmoid(x)
def _layernorm(x, axis=-1, eps=1e-5):
    m = x.mean(dim=axis, keepdim=True)
    v = x.var(dim=axis, keepdim=True, unbiased=False)
    return (x - m) / torch.sqrt(v + eps)
def _scatter_add(tgt, idx, src, axis=0):
    return tgt.clone().index_add_(axis, idx, src)
def _segment_sum(src, seg, n):
    out = torch.zeros((n,) + src.shape[1:], dtype=src.dtype)
    return out.index_add_(0, seg, src)
def _pad(x, pw):
    flat = tuple(v for pair in reversed(pw) for v in pair)
    return torch.nn.functional.pad(x, flat)

kernel_name = 'sequential_preLN__ssm_conv_s4d__moe_arch_mod__prompt'

def setup_inputs():

    _w = (lambda a: (lambda t: t.to(torch.bfloat16) if t.is_floating_point() else t)(torch.as_tensor(a)))
    def _A_setup():
        Bsz, L, D, N = 1, 2048, 640, 192
        return {
            "u": _w((lambda *s: torch.randn(*s, dtype=torch.bfloat16) * 0.05)(Bsz, L, D)),
            "log_A_real": _w((lambda *s: torch.randn(*s, dtype=torch.bfloat16) * 6.4)(D, N) * 0.5),
            "A_imag": _w((lambda *s: torch.randn(*s, dtype=torch.bfloat16) * 0.05)(D, N) * 3.14),
            "C_real": _w((lambda *s: torch.randn(*s, dtype=torch.bfloat16) * 0.05)(D, N) / N ** 0.5),
            "C_imag": _w((lambda *s: torch.randn(*s, dtype=torch.bfloat16) * 0.05)(D, N) / N ** 0.5),
            "log_dt": _w((lambda *s: torch.randn(*s, dtype=torch.bfloat16) * 0.05)(D) * 0.5 - 4.0),
            "D_skip": _w((lambda *s: torch.randn(*s, dtype=torch.bfloat16) * 0.05)(D)),
        }
    _A_in = _A_setup()

    def _B_setup():
        B, S, D, F, C = 1, 2048, 640, 1536, 8
        return {
            "x": _w((lambda *s: torch.randn(*s, dtype=torch.bfloat16) * 0.05)(B, S, D)),
            "w_r": _w((lambda *s: torch.randn(*s, dtype=torch.bfloat16) * 0.05)(D)),
            "w_gate": _w((lambda *s: torch.randn(*s, dtype=torch.bfloat16) * 0.05)(D, F)),
            "w_up": _w((lambda *s: torch.randn(*s, dtype=torch.bfloat16) * 0.05)(D, F)),
            "w_down": _w((lambda *s: torch.randn(*s, dtype=torch.bfloat16) * 0.05)(F, D)),
        }
    _B_in = _B_setup()

    return {
        "A_u": _A_in["u"],
        "A_log_A_real": _A_in["log_A_real"],
        "A_A_imag": _A_in["A_imag"],
        "A_C_real": _A_in["C_real"],
        "A_C_imag": _A_in["C_imag"],
        "A_log_dt": _A_in["log_dt"],
        "A_D_skip": _A_in["D_skip"],
        "B_x": _B_in["x"],
        "B_w_r": _B_in["w_r"],
        "B_w_gate": _B_in["w_gate"],
        "B_w_up": _B_in["w_up"],
        "B_w_down": _B_in["w_down"],
    }

def reference(A_u, A_log_A_real, A_A_imag, A_C_real, A_C_imag, A_log_dt, A_D_skip, B_x, B_w_r, B_w_gate, B_w_up, B_w_down):
    def _A_ref(u, log_A_real, A_imag, C_real, C_imag, log_dt, D_skip):
        L = u.shape[1]
        dt = torch.exp(log_dt)
        A = -torch.exp(log_A_real) + 1j * A_imag
        C = (C_real + 1j * C_imag) * dt[:, None]
        pos = (lambda x, dt: x.to(dt))(torch.arange(L), log_dt.dtype)
        P = torch.exp((A * dt[:, None])[:, :, None] * pos[None, None, :])
        K = 2.0 * torch.einsum("dn,dnl->dl", C, P).real
        L2 = 2 * L
        u_t = (lambda x, *d: x.permute(*d))(u, 0, 2, 1)
        Kf = (lambda x, *a, **k: torch.fft.rfft(x.float(), *a, **k))(K, L2)
        Uf = (lambda x, *a, **k: torch.fft.rfft(x.float(), *a, **k))(u_t, L2)
        y = (lambda x, *a, **k: torch.fft.irfft(x, *a, **k).to(torch.bfloat16))(Uf * Kf[None, :, :], L2)[:, :, :L]
        y = (lambda x, *d: x.permute(*d))(y, 0, 2, 1)
        return y + u * D_skip[None, None, :]

    def _B_ref(x, w_r, w_gate, w_up, w_down):
        B, S, D = x.shape
        C = 8
        r = x @ w_r
        idx = torch.argsort(-r, axis=-1)[:, :C]
        idx_e = (lambda x, n, axis: torch.repeat_interleave(x, n, dim=axis))(idx.reshape(B, C, 1), D, axis=2)
        x_sel = (lambda x, i, axis: torch.take_along_dim(x, i, dim=axis))(x, idx_e, axis=1)
        g = _silu(x_sel @ w_gate)
        u = x_sel @ w_up
        y = (g * u) @ w_down
        r_sel = _sigmoid((lambda x, i, axis: torch.take_along_dim(x, i, dim=axis))(r, idx, axis=1))
        y = y * r_sel.reshape(B, C, 1)
        b_off = (torch.arange(B) * S).reshape(B, 1)
        flat_idx = (idx + b_off).reshape(B * C)
        zero = (x * 0.0).reshape(B * S, D)
        upd = _scatter_add(zero, flat_idx, y.reshape(B * C, D), axis=0)
        return x + upd.reshape(B, S, D)

    x = A_u
    h = x + _A_ref(_layernorm(x, axis=-1), A_log_A_real, A_A_imag, A_C_real, A_C_imag, A_log_dt, A_D_skip)
    h2 = h + _B_ref(_layernorm(h, axis=-1), B_w_r, B_w_gate, B_w_up, B_w_down)
    return h2
```

```asm
; @launch kernel=ka_kernel grid=(256,1,1) block=(1024,1,1) lds=148480
; @launch kernel=kd_kernel grid=(256,1,1) block=(512,1,1) lds=18432
.amdgcn_target "amdgcn-amd-amdhsa--gfx950"
.text
.globl ka_kernel
.p2align 8
.type ka_kernel,@function
ka_kernel:
    s_cmp_ge_u32 s2, 256
    s_cbranch_scc1 KA_END
    s_load_dwordx16 s[16:31], s[0:1], 0
    s_load_dwordx4 s[44:47], s[0:1], 104
    v_lshrrev_b32 v1, 6, v0
    s_nop 0
    v_readfirstlane_b32 s3, v1
    v_and_b32 v2, 63, v0
    v_mov_b32 v3, 0
    v_lshlrev_b32 v4, 2, v2
    v_add_u32 v4, 135488, v4
    s_cmp_lg_u32 s3, 0
    s_cbranch_scc1 KA_NOZ
    s_mov_b64 exec, 0xffffffff
    ds_write_b32 v4, v3
    s_mov_b64 exec, -1
KA_NOZ:
    s_sub_u32 s4, s2, 96
    s_and_b32 s35, s4, 7
    s_lshl_b32 s35, s35, 1
    s_bfe_u32 s6, s4, 0x10003
    s_or_b32 s35, s35, s6
    s_andn2_b32 s6, s4, 15
    s_or_b32 s35, s35, s6
    s_sub_u32 s4, s3, 4
    s_mul_i32 s37, s4, 11
    s_lshr_b32 s37, s37, 5
    s_mul_i32 s36, s37, 3
    s_sub_u32 s36, s4, s36
    s_lshl_b32 s34, s35, 2
    s_add_u32 s34, s34, s37
    s_mul_i32 s7, s4, 9216
    s_mul_i32 s4, s34, 384
    s_lshr_b32 s5, s34, 1
    s_lshl_b32 s5, s5, 2
    s_lshl_b32 s8, s36, 7
    s_add_u32 s8, s8, s4
    v_lshlrev_b32 v3, 1, v2
    v_add_u32 v1, s8, v3
    v_add_u32 v3, s4, v3
    s_waitcnt lgkmcnt(0)
    s_mov_b32 s32, s46
    s_mov_b32 s33, s47
    s_cmp_lt_u32 s3, 4
    s_cbranch_scc1 KA_B0
    s_cmp_lt_u32 s2, 96
    s_cbranch_scc1 KA_B0
    s_load_dword s6, s[26:27], s5
    global_load_ushort v10, v1, s[18:19]
    global_load_ushort v11, v1, s[20:21]
    global_load_ushort v12, v1, s[22:23]
    global_load_ushort v13, v1, s[24:25]
    global_load_ushort v14, v3, s[22:23] offset:0
    global_load_ushort v17, v3, s[24:25] offset:0
    global_load_ushort v15, v3, s[22:23] offset:128
    global_load_ushort v18, v3, s[24:25] offset:128
    global_load_ushort v16, v3, s[22:23] offset:256
    global_load_ushort v19, v3, s[24:25] offset:256
KA_B0:
    s_barrier
    s_cmp_lt_u32 s3, 3
    s_cbranch_scc1 KA_LN1
    s_cmp_lg_u32 s3, 3
    s_cbranch_scc1 KA_NOTAG
    s_mov_b32 s14, 9601024
    s_load_dword s15, s[32:33], s14
    v_mov_b32 v18, 135584
    s_waitcnt lgkmcnt(0)
    s_mul_i32 s15, s15, 0x9E3779B1
    s_add_u32 s15, s15, 0x632BE5AB
    v_mov_b32 v19, s15
    ds_write_b32 v18, v19
    s_waitcnt lgkmcnt(0)
    v_mov_b32 v18, 135500
    v_mov_b32 v19, 1
    s_mov_b64 exec, 1
    ds_add_u32 v18, v19
    s_mov_b64 exec, -1
    s_cmp_ge_u32 s2, 96
    s_cbranch_scc1 KA_CONV
    s_branch KA_WTPOLL
KA_NOTAG:
    s_cmp_lt_u32 s2, 96
    s_cbranch_scc1 KA_WT0
    s_mov_b32 s90, 1069066811
    s_mov_b32 s91, 849703008
    s_mov_b32 s92, 1060205080
    v_and_b32 v3, 15, v2
    v_lshrrev_b32 v4, 4, v2
    s_cmp_eq_u32 s36, 1
    s_cbranch_scc1 KA_A1
    s_cmp_eq_u32 s36, 2
    s_cbranch_scc1 KA_A2
    v_lshrrev_b32 v5, 1, v4
    v_lshlrev_b32 v5, 7, v5
    v_lshl_add_u32 v5, v3, 3, v5
    v_and_b32 v6, 1, v4
    v_lshl_add_u32 v5, v6, 2, v5
    s_branch KA_A3
KA_A1:
    v_lshlrev_b32 v5, 1, v3
    v_add_u32 v5, v5, v4
    v_add_u32 v5, 384, v5
    v_lshlrev_b32 v6, 4, v4
    v_add_u32 v6, v6, v3
    v_add_u32 v6, 480, v6
    v_cmp_gt_u32 vcc, 2, v4
    s_nop 1
    v_cndmask_b32 v5, v6, v5, vcc
    s_branch KA_A3
KA_A2:
    v_lshlrev_b32 v5, 6, v4
    v_lshlrev_b32 v6, 2, v3
    v_add_u32 v5, v5, v6
    v_add_u32 v5, 256, v5
    v_lshlrev_b32 v6, 2, v2
    v_add_u32 v6, 520, v6
    v_cmp_gt_u32 vcc, 2, v4
    s_nop 1
    v_cndmask_b32 v5, v6, v5, vcc
    v_mov_b32 v6, 640
    v_cmp_eq_u32 vcc, 32, v2
    s_nop 1
    v_cndmask_b32 v5, v5, v6, vcc
KA_A3:
    s_mul_i32 s11, s37, 1600
    s_add_u32 s11, s11, 129024
    v_lshlrev_b32 v29, 1, v5
    v_add_u32 v29, s11, v29
    v_mul_u32_u24 v32, 288, v3
    v_lshlrev_b32 v5, 4, v4
    v_add_u32 v32, v32, v5
    v_add_u32 v32, s7, v32
    v_lshlrev_b32 v5, 2, v2
    v_add_u32 v120, s7, v5
    v_add_u32 v121, 1152, v120
    v_add_u32 v122, 2304, v120
    v_add_u32 v123, 3456, v120
    v_add_u32 v124, 4608, v120
    v_add_u32 v125, 5760, v120
    v_add_u32 v126, 6912, v120
    v_add_u32 v127, 8064, v120
    s_waitcnt lgkmcnt(0)
    s_bitcmp1_b32 s34, 0
    s_cbranch_scc1 KA_ODD
    s_lshl_b32 s6, s6, 16
KA_ODD:
    s_and_b32 s6, s6, 0xffff0000
    v_mov_b32 v5, s6
    v_mul_f32 v6, s90, v5
    v_fma_f32 v7, v5, s90, -v6
    v_fma_f32 v7, v5, s91, v7
    v_exp_f32 v33, v6
    v_mul_f32 v7, s92, v7
    v_fma_f32 v33, v33, v7, v33
    v_cvt_pk_bf16_f32 v33, v33, v33
    v_and_b32 v33, 0xffff0000, v33
    s_waitcnt vmcnt(0)
    v_and_b32 v14, 0x7fff, v14
    v_and_b32 v15, 0x7fff, v15
    v_and_b32 v16, 0x7fff, v16
    v_and_b32 v17, 0x7fff, v17
    v_and_b32 v18, 0x7fff, v18
    v_and_b32 v19, 0x7fff, v19
    v_max3_u32 v14, v14, v15, v16
    v_max3_u32 v17, v17, v18, v19
    v_max_u32 v14, v14, v17
    v_lshlrev_b32 v10, 16, v10
    v_lshlrev_b32 v11, 16, v11
    v_mul_f32 v6, s90, v10
    v_max_u32_dpp v14, v14, v14 row_shr:1 row_mask:0xf bank_mask:0xf
    v_fma_f32 v7, v10, s90, -v6
    v_exp_f32 v34, v6
    v_max_u32_dpp v14, v14, v14 row_shr:2 row_mask:0xf bank_mask:0xf
    v_fma_f32 v7, v10, s91, v7
    v_mul_f32 v35, v11, v33
    v_max_u32_dpp v14, v14, v14 row_shr:4 row_mask:0xf bank_mask:0xf
    v_mul_f32 v7, s92, v7
    v_mul_f32 v35, 1042479491, v35
    v_max_u32_dpp v14, v14, v14 row_shr:8 row_mask:0xf bank_mask:0xf
    v_fma_f32 v34, v34, v7, v34
    v_lshlrev_b32 v12, 16, v12
    v_max_u32_dpp v14, v14, v14 row_bcast:15 row_mask:0xa bank_mask:0xf
    v_cvt_pk_bf16_f32 v34, v34, v34
    v_lshlrev_b32 v13, 16, v13
    v_max_u32_dpp v14, v14, v14 row_bcast:31 row_mask:0xc bank_mask:0xf
    v_and_b32 v34, 0xffff0000, v34
    v_mul_f32 v34, v34, v33
    v_readlane_b32 s8, v14, 63
    v_mul_f32 v34, s90, v34
    v_sub_f32 v34, 0, v34
    s_lshr_b32 s8, s8, 7
    s_max_u32 s8, s8, 6
    s_min_u32 s8, s8, 253
    s_sub_u32 s9, 260, s8
    s_lshl_b32 s9, s9, 23
    s_sub_u32 s10, s8, 132
    v_mul_f32 v62, 1.0, v34
    v_mul_f32 v63, 1.0, v35
    v_fract_f32 v63, v63
    v_mul_f32 v66, 0x41000000, v34
    v_mul_f32 v67, 0x41000000, v35
    v_fract_f32 v67, v67
    v_mul_f32 v70, 0x43000000, v34
    v_mul_f32 v71, 0x43000000, v35
    v_fract_f32 v71, v71
    v_exp_f32 v62, v62
    v_cos_f32 v64, v63
    v_sin_f32 v65, v63
    v_exp_f32 v66, v66
    v_cos_f32 v68, v67
    v_sin_f32 v69, v67
    v_exp_f32 v70, v70
    v_cos_f32 v72, v71
    v_sin_f32 v73, v71
    v_mul_f32 v36, s9, v12
    v_mul_f32 v37, s9, v13
    v_ldexp_f32 v6, v33, s10
    s_lshl_b32 s11, s37, 2
    s_add_u32 s11, s11, 135424
    v_mov_b32 v7, s11
    ds_write_b32 v7, v6
    v_mul_f32 v38, v62, v64
    v_mul_f32 v39, v62, v65
    v_mul_f32 v52, v66, v68
    v_mul_f32 v53, v66, v69
    v_mul_f32 v54, v70, v72
    v_mul_f32 v55, v70, v73
    v_pk_mul_f32 v[40:41], v[38:39], v[38:39] op_sel:[0,0] op_sel_hi:[0,1]
    v_pk_mul_f32 v[102:103], v[52:53], v[52:53] op_sel:[0,0] op_sel_hi:[0,1]
    v_pk_mul_f32 v[56:57], v[54:55], v[54:55] op_sel:[0,0] op_sel_hi:[0,1]
    v_pk_fma_f32 v[40:41], v[38:39], v[38:39], v[40:41] op_sel:[1,1,0] op_sel_hi:[1,0,1] neg_lo:[0,1,0]
    v_pk_fma_f32 v[102:103], v[52:53], v[52:53], v[102:103] op_sel:[1,1,0] op_sel_hi:[1,0,1] neg_lo:[0,1,0]
    v_pk_fma_f32 v[56:57], v[54:55], v[54:55], v[56:57] op_sel:[1,1,0] op_sel_hi:[1,0,1] neg_lo:[0,1,0]
    v_pk_mul_f32 v[42:43], v[40:41], v[38:39] op_sel:[0,0] op_sel_hi:[0,1]
    v_pk_mul_f32 v[44:45], v[40:41], v[40:41] op_sel:[0,0] op_sel_hi:[0,1]
    v_pk_mul_f32 v[104:105], v[102:103], v[52:53] op_sel:[0,0] op_sel_hi:[0,1]
    v_pk_mul_f32 v[106:107], v[102:103], v[102:103] op_sel:[0,0] op_sel_hi:[0,1]
    v_pk_mul_f32 v[58:59], v[56:57], v[56:57] op_sel:[0,0] op_sel_hi:[0,1]
    v_pk_fma_f32 v[42:43], v[40:41], v[38:39], v[42:43] op_sel:[1,1,0] op_sel_hi:[1,0,1] neg_lo:[0,1,0]
    v_pk_fma_f32 v[44:45], v[40:41], v[40:41], v[44:45] op_sel:[1,1,0] op_sel_hi:[1,0,1] neg_lo:[0,1,0]
    v_pk_fma_f32 v[104:105], v[102:103], v[52:53], v[104:105] op_sel:[1,1,0] op_sel_hi:[1,0,1] neg_lo:[0,1,0]
    v_pk_fma_f32 v[106:107], v[102:103], v[102:103], v[106:107] op_sel:[1,1,0] op_sel_hi:[1,0,1] neg_lo:[0,1,0]
    v_pk_fma_f32 v[58:59], v[56:57], v[56:57], v[58:59] op_sel:[1,1,0] op_sel_hi:[1,0,1] neg_lo:[0,1,0]
    v_pk_mul_f32 v[46:47], v[44:45], v[38:39] op_sel:[0,0] op_sel_hi:[0,1]
    v_pk_mul_f32 v[48:49], v[44:45], v[40:41] op_sel:[0,0] op_sel_hi:[0,1]
    v_pk_mul_f32 v[50:51], v[44:45], v[42:43] op_sel:[0,0] op_sel_hi:[0,1]
    v_pk_mul_f32 v[108:109], v[106:107], v[52:53] op_sel:[0,0] op_sel_hi:[0,1]
    v_pk_mul_f32 v[110:111], v[106:107], v[102:103] op_sel:[0,0] op_sel_hi:[0,1]
    v_pk_mul_f32 v[112:113], v[106:107], v[104:105] op_sel:[0,0] op_sel_hi:[0,1]
    v_pk_mul_f32 v[114:115], v[106:107], v[106:107] op_sel:[0,0] op_sel_hi:[0,1]
    v_pk_mul_f32 v[60:61], v[58:59], v[58:59] op_sel:[0,0] op_sel_hi:[0,1]
    v_pk_fma_f32 v[46:47], v[44:45], v[38:39], v[46:47] op_sel:[1,1,0] op_sel_hi:[1,0,1] neg_lo:[0,1,0]
    v_pk_fma_f32 v[48:49], v[44:45], v[40:41], v[48:49] op_sel:[1,1,0] op_sel_hi:[1,0,1] neg_lo:[0,1,0]
    v_pk_fma_f32 v[50:51], v[44:45], v[42:43], v[50:51] op_sel:[1,1,0] op_sel_hi:[1,0,1] neg_lo:[0,1,0]
    v_pk_fma_f32 v[108:109], v[106:107], v[52:53], v[108:109] op_sel:[1,1,0] op_sel_hi:[1,0,1] neg_lo:[0,1,0]
    v_pk_fma_f32 v[110:111], v[106:107], v[102:103], v[110:111] op_sel:[1,1,0] op_sel_hi:[1,0,1] neg_lo:[0,1,0]
    v_pk_fma_f32 v[112:113], v[106:107], v[104:105], v[112:113] op_sel:[1,1,0] op_sel_hi:[1,0,1] neg_lo:[0,1,0]
    v_pk_fma_f32 v[114:115], v[106:107], v[106:107], v[114:115] op_sel:[1,1,0] op_sel_hi:[1,0,1] neg_lo:[0,1,0]
    v_pk_fma_f32 v[60:61], v[58:59], v[58:59], v[60:61] op_sel:[1,1,0] op_sel_hi:[1,0,1] neg_lo:[0,1,0]
    v_mov_b32 v20, 0
    v_mov_b32 v24, 0
    v_mov_b32 v4, 0
    v_mov_b32 v21, 0
    v_mov_b32 v25, 0
    v_mov_b32 v5, 0
    v_mov_b32 v22, 0
    v_mov_b32 v26, 0
    v_mov_b32 v6, 0
    v_mov_b32 v23, 0
    v_mov_b32 v27, 0
    v_mov_b32 v7, 0
    v_mov_b32 v78, 0x00003c00
    v_cvt_pk_f16_f32 v79, v52, v53
    v_cvt_pk_f16_f32 v80, v102, v103
    v_cvt_pk_f16_f32 v81, v104, v105
    v_cvt_pk_f16_f32 v82, v106, v107
    v_cvt_pk_f16_f32 v83, v108, v109
    v_cvt_pk_f16_f32 v84, v110, v111
    v_cvt_pk_f16_f32 v85, v112, v113
    ds_write2_b32 v120, v78, v79 offset0:0 offset1:72
    ds_write2_b32 v120, v80, v81 offset0:144 offset1:216
    ds_write2_b32 v121, v82, v83 offset0:0 offset1:72
    ds_write2_b32 v121, v84, v85 offset0:144 offset1:216
    v_pk_mul_f32 v[62:63], v[114:115], v[52:53] op_sel:[0,0] op_sel_hi:[0,1]
    v_pk_mul_f32 v[64:65], v[114:115], v[102:103] op_sel:[0,0] op_sel_hi:[0,1]
    v_pk_mul_f32 v[66:67], v[114:115], v[104:105] op_sel:[0,0] op_sel_hi:[0,1]
    v_pk_mul_f32 v[68:69], v[114:115], v[106:107] op_sel:[0,0] op_sel_hi:[0,1]
    v_pk_mul_f32 v[70:71], v[114:115], v[108:109] op_sel:[0,0] op_sel_hi:[0,1]
    v_pk_mul_f32 v[72:73], v[114:115], v[110:111] op_sel:[0,0] op_sel_hi:[0,1]
    v_pk_mul_f32 v[74:75], v[114:115], v[112:113] op_sel:[0,0] op_sel_hi:[0,1]
    v_pk_fma_f32 v[62:63], v[114:115], v[52:53], v[62:63] op_sel:[1,1,0] op_sel_hi:[1,0,1] neg_lo:[0,1,0]
    v_pk_fma_f32 v[64:65], v[114:115], v[102:103], v[64:65] op_sel:[1,1,0] op_sel_hi:[1,0,1] neg_lo:[0,1,0]
    v_pk_fma_f32 v[66:67], v[114:115], v[104:105], v[66:67] op_sel:[1,1,0] op_sel_hi:[1,0,1] neg_lo:[0,1,0]
    v_pk_fma_f32 v[68:69], v[114:115], v[106:107], v[68:69] op_sel:[1,1,0] op_sel_hi:[1,0,1] neg_lo:[0,1,0]
    v_pk_fma_f32 v[70:71], v[114:115], v[108:109], v[70:71] op_sel:[1,1,0] op_sel_hi:[1,0,1] neg_lo:[0,1,0]
    v_pk_fma_f32 v[72:73], v[114:115], v[110:111], v[72:73] op_sel:[1,1,0] op_sel_hi:[1,0,1] neg_lo:[0,1,0]
    v_pk_fma_f32 v[74:75], v[114:115], v[112:113], v[74:75] op_sel:[1,1,0] op_sel_hi:[1,0,1] neg_lo:[0,1,0]
    v_cvt_pk_f16_f32 v78, v114, v115
    v_cvt_pk_f16_f32 v79, v62, v63
    v_cvt_pk_f16_f32 v80, v64, v65
    v_cvt_pk_f16_f32 v81, v66, v67
    v_cvt_pk_f16_f32 v82, v68, v69
    v_cvt_pk_f16_f32 v83, v70, v71
    v_cvt_pk_f16_f32 v84, v72, v73
    v_cvt_pk_f16_f32 v85, v74, v75
    ds_write2_b32 v122, v78, v79 offset0:0 offset1:72
    ds_write2_b32 v122, v80, v81 offset0:144 offset1:216
    ds_write2_b32 v123, v82, v83 offset0:0 offset1:72
    ds_write2_b32 v123, v84, v85 offset0:144 offset1:216
    ds_read_b128 v[86:89], v32 offset:0
    ds_read_b128 v[90:93], v32 offset:64
    ds_read_b128 v[94:97], v32 offset:128
    ds_read_b128 v[98:101], v32 offset:192
    v_pk_mul_f32 v[62:63], v[36:37], v[38:39] op_sel:[0,0] op_sel_hi:[0,1]
    v_pk_mul_f32 v[64:65], v[36:37], v[40:41] op_sel:[0,0] op_sel_hi:[0,1]
    v_pk_mul_f32 v[66:67], v[36:37], v[42:43] op_sel:[0,0] op_sel_hi:[0,1]
    v_pk_mul_f32 v[68:69], v[36:37], v[44:45] op_sel:[0,0] op_sel_hi:[0,1]
    v_pk_mul_f32 v[70:71], v[36:37], v[46:47] op_sel:[0,0] op_sel_hi:[0,1]
    v_pk_mul_f32 v[72:73], v[36:37], v[48:49] op_sel:[0,0] op_sel_hi:[0,1]
    v_pk_mul_f32 v[74:75], v[36:37], v[50:51] op_sel:[0,0] op_sel_hi:[0,1]
    v_pk_mul_f32 v[76:77], v[36:37], v[54:55] op_sel:[0,0] op_sel_hi:[0,1]
    v_pk_fma_f32 v[62:63], v[36:37], v[38:39], v[62:63] op_sel:[1,1,0] op_sel_hi:[1,0,1] neg_lo:[0,1,0]
    v_pk_fma_f32 v[64:65], v[36:37], v[40:41], v[64:65] op_sel:[1,1,0] op_sel_hi:[1,0,1] neg_lo:[0,1,0]
    v_pk_fma_f32 v[66:67], v[36:37], v[42:43], v[66:67] op_sel:[1,1,0] op_sel_hi:[1,0,1] neg_lo:[0,1,0]
    v_pk_fma_f32 v[68:69], v[36:37], v[44:45], v[68:69] op_sel:[1,1,0] op_sel_hi:[1,0,1] neg_lo:[0,1,0]
    v_pk_fma_f32 v[70:71], v[36:37], v[46:47], v[70:71] op_sel:[1,1,0] op_sel_hi:[1,0,1] neg_lo:[0,1,0]
    v_pk_fma_f32 v[72:73], v[36:37], v[48:49], v[72:73] op_sel:[1,1,0] op_sel_hi:[1,0,1] neg_lo:[0,1,0]
    v_pk_fma_f32 v[74:75], v[36:37], v[50:51], v[74:75] op_sel:[1,1,0] op_sel_hi:[1,0,1] neg_lo:[0,1,0]
    v_pk_fma_f32 v[76:77], v[36:37], v[54:55], v[76:77] op_sel:[1,1,0] op_sel_hi:[1,0,1] neg_lo:[0,1,0]
    v_cvt_pk_f16_f32 v78, v36, -v37
    v_cvt_pk_f16_f32 v79, v62, -v63
    v_cvt_pk_f16_f32 v80, v64, -v65
    v_cvt_pk_f16_f32 v81, v66, -v67
    v_cvt_pk_f16_f32 v82, v68, -v69
    v_cvt_pk_f16_f32 v83, v70, -v71
    v_cvt_pk_f16_f32 v84, v72, -v73
    v_cvt_pk_f16_f32 v85, v74, -v75
    ds_write2_b32 v124, v78, v79 offset0:0 offset1:72
    ds_write2_b32 v124, v80, v81 offset0:144 offset1:216
    ds_write2_b32 v125, v82, v83 offset0:0 offset1:72
    ds_write2_b32 v125, v84, v85 offset0:144 offset1:216
    v_pk_mul_f32 v[62:63], v[76:77], v[38:39] op_sel:[0,0] op_sel_hi:[0,1]
    v_pk_mul_f32 v[64:65], v[76:77], v[40:41] op_sel:[0,0] op_sel_hi:[0,1]
    v_pk_mul_f32 v[66:67], v[76:77], v[42:43] op_sel:[0,0] op_sel_hi:[0,1]
    v_pk_mul_f32 v[68:69], v[76:77], v[44:45] op_sel:[0,0] op_sel_hi:[0,1]
    v_pk_mul_f32 v[70:71], v[76:77], v[46:47] op_sel:[0,0] op_sel_hi:[0,1]
    v_pk_mul_f32 v[72:73], v[76:77], v[48:49] op_sel:[0,0] op_sel_hi:[0,1]
    v_pk_mul_f32 v[74:75], v[76:77], v[50:51] op_sel:[0,0] op_sel_hi:[0,1]
    v_pk_fma_f32 v[62:63], v[76:77], v[38:39], v[62:63] op_sel:[1,1,0] op_sel_hi:[1,0,1] neg_lo:[0,1,0]
    v_pk_fma_f32 v[64:65], v[76:77], v[40:41], v[64:65] op_sel:[1,1,0] op_sel_hi:[1,0,1] neg_lo:[0,1,0]
    v_pk_fma_f32 v[66:67], v[76:77], v[42:43], v[66:67] op_sel:[1,1,0] op_sel_hi:[1,0,1] neg_lo:[0,1,0]
    v_pk_fma_f32 v[68:69], v[76:77], v[44:45], v[68:69] op_sel:[1,1,0] op_sel_hi:[1,0,1] neg_lo:[0,1,0]
    v_pk_fma_f32 v[70:71], v[76:77], v[46:47], v[70:71] op_sel:[1,1,0] op_sel_hi:[1,0,1] neg_lo:[0,1,0]
    v_pk_fma_f32 v[72:73], v[76:77], v[48:49], v[72:73] op_sel:[1,1,0] op_sel_hi:[1,0,1] neg_lo:[0,1,0]
    v_pk_fma_f32 v[74:75], v[76:77], v[50:51], v[74:75] op_sel:[1,1,0] op_sel_hi:[1,0,1] neg_lo:[0,1,0]
    v_cvt_pk_f16_f32 v78, v76, -v77
    v_cvt_pk_f16_f32 v79, v62, -v63
    v_cvt_pk_f16_f32 v80, v64, -v65
    v_cvt_pk_f16_f32 v81, v66, -v67
    v_cvt_pk_f16_f32 v82, v68, -v69
    v_cvt_pk_f16_f32 v83, v70, -v71
    v_cvt_pk_f16_f32 v84, v72, -v73
    v_cvt_pk_f16_f32 v85, v74, -v75
    ds_write2_b32 v126, v78, v79 offset0:0 offset1:72
    ds_write2_b32 v126, v80, v81 offset0:144 offset1:216
    ds_write2_b32 v127, v82, v83 offset0:0 offset1:72
    ds_write2_b32 v127, v84, v85 offset0:144 offset1:216
    ds_read_b128 v[102:105], v32 offset:4608
    ds_read_b128 v[106:109], v32 offset:4672
    ds_read_b128 v[110:113], v32 offset:4736
    ds_read_b128 v[114:117], v32 offset:4800
    v_pk_mul_f32 v[62:63], v[36:37], v[58:59] op_sel:[0,0] op_sel_hi:[0,1]
    v_pk_mul_f32 v[70:71], v[36:37], v[60:61] op_sel:[0,0] op_sel_hi:[0,1]
    v_pk_fma_f32 v[62:63], v[36:37], v[58:59], v[62:63] op_sel:[1,1,0] op_sel_hi:[1,0,1] neg_lo:[0,1,0]
    v_pk_fma_f32 v[70:71], v[36:37], v[60:61], v[70:71] op_sel:[1,1,0] op_sel_hi:[1,0,1] neg_lo:[0,1,0]
    v_pk_mul_f32 v[64:65], v[62:63], v[54:55] op_sel:[0,0] op_sel_hi:[0,1]
    v_pk_mul_f32 v[66:67], v[62:63], v[56:57] op_sel:[0,0] op_sel_hi:[0,1]
    v_pk_mul_f32 v[72:73], v[70:71], v[56:57] op_sel:[0,0] op_sel_hi:[0,1]
    v_pk_mul_f32 v[74:75], v[70:71], v[58:59] op_sel:[0,0] op_sel_hi:[0,1]
    v_pk_fma_f32 v[64:65], v[62:63], v[54:55], v[64:65] op_sel:[1,1,0] op_sel_hi:[1,0,1] neg_lo:[0,1,0]
    v_pk_fma_f32 v[66:67], v[62:63], v[56:57], v[66:67] op_sel:[1,1,0] op_sel_hi:[1,0,1] neg_lo:[0,1,0]
    v_pk_fma_f32 v[72:73], v[70:71], v[56:57], v[72:73] op_sel:[1,1,0] op_sel_hi:[1,0,1] neg_lo:[0,1,0]
    v_pk_fma_f32 v[74:75], v[70:71], v[58:59], v[74:75] op_sel:[1,1,0] op_sel_hi:[1,0,1] neg_lo:[0,1,0]
    v_pk_mul_f32 v[68:69], v[66:67], v[54:55] op_sel:[0,0] op_sel_hi:[0,1]
    v_pk_mul_f32 v[76:77], v[74:75], v[56:57] op_sel:[0,0] op_sel_hi:[0,1]
    v_pk_fma_f32 v[68:69], v[66:67], v[54:55], v[68:69] op_sel:[1,1,0] op_sel_hi:[1,0,1] neg_lo:[0,1,0]
    v_pk_fma_f32 v[76:77], v[74:75], v[56:57], v[76:77] op_sel:[1,1,0] op_sel_hi:[1,0,1] neg_lo:[0,1,0]
    v_cvt_pk_f16_f32 v78, v62, -v63
    v_cvt_pk_f16_f32 v79, v64, -v65
    v_cvt_pk_f16_f32 v80, v66, -v67
    v_cvt_pk_f16_f32 v81, v68, -v69
    v_cvt_pk_f16_f32 v82, v70, -v71
    v_cvt_pk_f16_f32 v83, v72, -v73
    v_cvt_pk_f16_f32 v84, v74, -v75
    v_cvt_pk_f16_f32 v85, v76, -v77
    ds_write2_b32 v120, v78, v79 offset0:0 offset1:72
    ds_write2_b32 v120, v80, v81 offset0:144 offset1:216
    ds_write2_b32 v122, v82, v83 offset0:0 offset1:72
    ds_write2_b32 v122, v84, v85 offset0:144 offset1:216
    v_pk_mul_f32 v[38:39], v[70:71], v[60:61] op_sel:[0,0] op_sel_hi:[0,1]
    v_pk_fma_f32 v[38:39], v[70:71], v[60:61], v[38:39] op_sel:[1,1,0] op_sel_hi:[1,0,1] neg_lo:[0,1,0]
    v_pk_mul_f32 v[42:43], v[62:63], v[44:45] op_sel:[0,0] op_sel_hi:[0,1]
    v_pk_mul_f32 v[46:47], v[64:65], v[44:45] op_sel:[0,0] op_sel_hi:[0,1]
    v_pk_mul_f32 v[50:51], v[66:67], v[44:45] op_sel:[0,0] op_sel_hi:[0,1]
    v_pk_mul_f32 v[52:53], v[68:69], v[44:45] op_sel:[0,0] op_sel_hi:[0,1]
    v_pk_fma_f32 v[42:43], v[62:63], v[44:45], v[42:43] op_sel:[1,1,0] op_sel_hi:[1,0,1] neg_lo:[0,1,0]
    v_pk_fma_f32 v[46:47], v[64:65], v[44:45], v[46:47] op_sel:[1,1,0] op_sel_hi:[1,0,1] neg_lo:[0,1,0]
    v_pk_fma_f32 v[50:51], v[66:67], v[44:45], v[50:51] op_sel:[1,1,0] op_sel_hi:[1,0,1] neg_lo:[0,1,0]
    v_pk_fma_f32 v[52:53], v[68:69], v[44:45], v[52:53] op_sel:[1,1,0] op_sel_hi:[1,0,1] neg_lo:[0,1,0]
    s_waitcnt lgkmcnt(4)
    v_mfma_f32_16x16x32_f16 v[20:23], v[102:105], v[86:89], v[20:23]
    v_mfma_f32_16x16x32_f16 v[20:23], v[106:109], v[90:93], v[20:23]
    v_mfma_f32_16x16x32_f16 v[20:23], v[110:113], v[94:97], v[20:23]
    v_mfma_f32_16x16x32_f16 v[20:23], v[114:117], v[98:101], v[20:23]
    v_pk_mul_f32 v[62:63], v[70:71], v[54:55] op_sel:[0,0] op_sel_hi:[0,1]
    v_pk_mul_f32 v[64:65], v[72:73], v[54:55] op_sel:[0,0] op_sel_hi:[0,1]
    v_pk_mul_f32 v[66:67], v[74:75], v[54:55] op_sel:[0,0] op_sel_hi:[0,1]
    v_pk_mul_f32 v[68:69], v[76:77], v[54:55] op_sel:[0,0] op_sel_hi:[0,1]
    v_pk_fma_f32 v[62:63], v[70:71], v[54:55], v[62:63] op_sel:[1,1,0] op_sel_hi:[1,0,1] neg_lo:[0,1,0]
    v_pk_fma_f32 v[64:65], v[72:73], v[54:55], v[64:65] op_sel:[1,1,0] op_sel_hi:[1,0,1] neg_lo:[0,1,0]
    v_pk_fma_f32 v[66:67], v[74:75], v[54:55], v[66:67] op_sel:[1,1,0] op_sel_hi:[1,0,1] neg_lo:[0,1,0]
    v_pk_fma_f32 v[68:69], v[76:77], v[54:55], v[68:69] op_sel:[1,1,0] op_sel_hi:[1,0,1] neg_lo:[0,1,0]
    v_cvt_pk_f16_f32 v78, v42, -v43
    v_cvt_pk_f16_f32 v79, v46, -v47
    v_cvt_pk_f16_f32 v80, v50, -v51
    v_cvt_pk_f16_f32 v81, v52, -v53
    v_cvt_pk_f16_f32 v82, v62, -v63
    v_cvt_pk_f16_f32 v83, v64, -v65
    v_cvt_pk_f16_f32 v84, v66, -v67
    v_cvt_pk_f16_f32 v85, v68, -v69
    ds_write2_b32 v121, v78, v79 offset0:0 offset1:72
    ds_write2_b32 v121, v80, v81 offset0:144 offset1:216
    ds_write2_b32 v123, v82, v83 offset0:0 offset1:72
    ds_write2_b32 v123, v84, v85 offset0:144 offset1:216
    ds_read_b128 v[102:105], v32 offset:0
    ds_read_b128 v[106:109], v32 offset:64
    ds_read_b128 v[110:113], v32 offset:128
    ds_read_b128 v[114:117], v32 offset:192
    v_pk_mul_f32 v[62:63], v[36:37], v[56:57] op_sel:[0,0] op_sel_hi:[0,1]
    v_pk_fma_f32 v[62:63], v[36:37], v[56:57], v[62:63] op_sel:[1,1,0] op_sel_hi:[1,0,1] neg_lo:[0,1,0]
    v_pk_mul_f32 v[70:71], v[62:63], v[54:55] op_sel:[0,0] op_sel_hi:[0,1]
    v_pk_mul_f32 v[64:65], v[62:63], v[40:41] op_sel:[0,0] op_sel_hi:[0,1]
    v_pk_mul_f32 v[66:67], v[62:63], v[44:45] op_sel:[0,0] op_sel_hi:[0,1]
    v_pk_mul_f32 v[68:69], v[62:63], v[48:49] op_sel:[0,0] op_sel_hi:[0,1]
    v_pk_fma_f32 v[70:71], v[62:63], v[54:55], v[70:71] op_sel:[1,1,0] op_sel_hi:[1,0,1] neg_lo:[0,1,0]
    v_pk_fma_f32 v[64:65], v[62:63], v[40:41], v[64:65] op_sel:[1,1,0] op_sel_hi:[1,0,1] neg_lo:[0,1,0]
    v_pk_fma_f32 v[66:67], v[62:63], v[44:45], v[66:67] op_sel:[1,1,0] op_sel_hi:[1,0,1] neg_lo:[0,1,0]
    v_pk_fma_f32 v[68:69], v[62:63], v[48:49], v[68:69] op_sel:[1,1,0] op_sel_hi:[1,0,1] neg_lo:[0,1,0]
    v_pk_mul_f32 v[72:73], v[70:71], v[40:41] op_sel:[0,0] op_sel_hi:[0,1]
    v_pk_mul_f32 v[74:75], v[70:71], v[44:45] op_sel:[0,0] op_sel_hi:[0,1]
    v_pk_mul_f32 v[76:77], v[70:71], v[48:49] op_sel:[0,0] op_sel_hi:[0,1]
    v_pk_fma_f32 v[72:73], v[70:71], v[40:41], v[72:73] op_sel:[1,1,0] op_sel_hi:[1,0,1] neg_lo:[0,1,0]
    v_pk_fma_f32 v[74:75], v[70:71], v[44:45], v[74:75] op_sel:[1,1,0] op_sel_hi:[1,0,1] neg_lo:[0,1,0]
    v_pk_fma_f32 v[76:77], v[70:71], v[48:49], v[76:77] op_sel:[1,1,0] op_sel_hi:[1,0,1] neg_lo:[0,1,0]
    v_cvt_pk_f16_f32 v78, v62, -v63
    v_cvt_pk_f16_f32 v79, v64, -v65
    v_cvt_pk_f16_f32 v80, v66, -v67
    v_cvt_pk_f16_f32 v81, v68, -v69
    v_cvt_pk_f16_f32 v82, v70, -v71
    v_cvt_pk_f16_f32 v83, v72, -v73
    v_cvt_pk_f16_f32 v84, v74, -v75
    v_cvt_pk_f16_f32 v85, v76, -v77
    ds_write2_b32 v124, v78, v79 offset0:0 offset1:72
    ds_write2_b32 v124, v80, v81 offset0:144 offset1:216
    ds_write2_b32 v125, v82, v83 offset0:0 offset1:72
    ds_write2_b32 v125, v84, v85 offset0:144 offset1:216
    v_cvt_pk_f16_f32 v78, v38, -v39
    ds_write_b32 v126, v78 offset:0
    s_waitcnt lgkmcnt(5)
    v_mfma_f32_16x16x32_f16 v[24:27], v[102:105], v[86:89], v[24:27]
    v_mfma_f32_16x16x32_f16 v[24:27], v[106:109], v[90:93], v[24:27]
    v_mfma_f32_16x16x32_f16 v[24:27], v[110:113], v[94:97], v[24:27]
    v_mfma_f32_16x16x32_f16 v[24:27], v[114:117], v[98:101], v[24:27]
    ds_read_b128 v[62:65], v32 offset:4608
    ds_read_b128 v[66:69], v32 offset:4672
    ds_read_b128 v[70:73], v32 offset:4736
    ds_read_b128 v[74:77], v32 offset:4800
    s_waitcnt lgkmcnt(0)
    v_mfma_f32_16x16x32_f16 v[4:7], v[62:65], v[86:89], v[4:7]
    v_mfma_f32_16x16x32_f16 v[4:7], v[66:69], v[90:93], v[4:7]
    v_mfma_f32_16x16x32_f16 v[4:7], v[70:73], v[94:97], v[4:7]
    v_mfma_f32_16x16x32_f16 v[4:7], v[74:77], v[98:101], v[4:7]
    v_lshlrev_b32 v28, 4, v2
    v_add_u32 v30, s7, v28
    ds_write_b128 v30, v[20:23] offset:0
    ds_write_b128 v30, v[24:27] offset:1024
    s_nop 3
    ds_write_b128 v30, v[4:7] offset:2048
    s_waitcnt lgkmcnt(0)
    s_lshl_b32 s12, s37, 2
    s_add_u32 s12, s12, 135504
    v_mov_b32 v18, s12
    v_mov_b32 v19, 1
    s_mov_b64 exec, 1
    ds_add_u32 v18, v19
    s_mov_b64 exec, -1
    s_lshl_b32 s12, s37, 2
    s_add_u32 s12, s12, 135504
    v_mov_b32 v18, s12
    s_mov_b32 s12, 0
KA_W4:
    ds_read_b32 v19, v18
    s_waitcnt lgkmcnt(0)
    v_readfirstlane_b32 s13, v19
    s_nop 0
    s_cmp_ge_u32 s13, 3
    s_cbranch_scc1 KA_W4_OK
    s_add_u32 s12, s12, 1
    s_sleep 1
    s_cmp_lt_u32 s12, 4194304
    s_cbranch_scc1 KA_W4
KA_W4_OK:
    s_mul_i32 s11, s37, 27648
    s_lshl_b32 s12, s36, 10
    s_add_u32 s11, s11, s12
    v_add_u32 v28, s11, v28
    ds_read_b128 v[40:43], v28 offset:0
    ds_read_b128 v[44:47], v28 offset:9216
    ds_read_b128 v[48:51], v28 offset:18432
    s_waitcnt lgkmcnt(0)
    v_add_f32 v40, v40, v44
    v_add_f32 v41, v41, v45
    v_add_f32 v42, v42, v46
    v_add_f32 v43, v43, v47
    v_add_f32 v40, v40, v48
    v_add_f32 v41, v41, v49
    v_add_f32 v42, v42, v50
    v_add_f32 v43, v43, v51
    v_cvt_pk_f16_f32 v40, v40, v41
    v_cvt_pk_f16_f32 v41, v42, v43
    s_cmp_eq_u32 s36, 1
    s_cbranch_scc1 KA_S1
    ds_write_b64 v29, v[40:41]
    s_branch KA_S2
KA_S1:
    ds_write_b16 v29, v40
    ds_write_b16_d16_hi v29, v40 offset:64
    ds_write_b16 v29, v41 offset:128
    ds_write_b16_d16_hi v29, v41 offset:192
KA_S2:
    s_waitcnt lgkmcnt(0)
    s_lshl_b32 s12, s37, 2
    s_add_u32 s12, s12, 135520
    v_mov_b32 v18, s12
    v_mov_b32 v19, 1
    s_mov_b64 exec, 1
    ds_add_u32 v18, v19
    s_mov_b64 exec, -1
    s_lshl_b32 s12, s37, 2
    s_add_u32 s12, s12, 135520
    v_mov_b32 v18, s12
    s_mov_b32 s12, 0
KA_W5:
    ds_read_b32 v19, v18
    s_waitcnt lgkmcnt(0)
    v_readfirstlane_b32 s13, v19
    s_nop 0
    s_cmp_ge_u32 s13, 3
    s_cbranch_scc1 KA_W5_OK
    s_add_u32 s12, s12, 1
    s_sleep 1
    s_cmp_lt_u32 s12, 4194304
    s_cbranch_scc1 KA_W5
KA_W5_OK:
    s_mul_i32 s39, s37, 27712
    s_add_u32 s39, s39, 0
    s_mul_i32 s40, s37, 1600
    s_add_u32 s40, s40, 129024
    s_cmp_eq_u32 s36, 0
    s_cbranch_scc1 KA_R0
    s_cmp_eq_u32 s36, 1
    s_cbranch_scc1 KA_R1
    v_lshlrev_b32 v28, 4, v2
    v_add_u32 v28, s39, v28
    s_mov_b32 s22, 0x01000100
    s_mov_b32 s23, 0x03020302
    v_lshlrev_b32 v27, 2, v2
    v_sub_u32 v27, 1020, v27
    v_add_u32 v27, s40, v27
    ds_read_b32 v56, v27
    ds_read_u16 v57, v27 offset:4
    s_mov_b32 s24, 0x07060100
    s_waitcnt lgkmcnt(0)
    v_perm_b32 v40, v57, v57, s22
    v_perm_b32 v41, v56, v56, s23
    v_alignbit_b32 v42, v56, v56, 16
    v_perm_b32 v43, v56, v56, s22
    v_perm_b32 v44, v56, v57, s24
    v_mov_b32 v45, v41
    v_mov_b32 v46, v43
    v_mov_b32 v47, v43
    ds_write_b128 v28, v[40:43] offset:2048
    ds_write_b128 v28, v[44:47] offset:6208
    s_branch KA_RX
KA_R0:
    v_lshlrev_b32 v28, 4, v2
    v_add_u32 v28, s39, v28
    s_mov_b32 s22, 0x01000100
    s_mov_b32 s23, 0x03020302
    v_lshlrev_b32 v26, 1, v2
    v_sub_u32 v26, 1278, v26
    v_add_u32 v26, s40, v26
    ds_read_u16 v40, v26
    ds_read_u16 v41, v26 offset:2
    v_and_b32 v16, 1, v2
    v_cmp_eq_u32 s[20:21], 1, v16
    s_waitcnt lgkmcnt(0)
    v_lshl_or_b32 v40, v41, 16, v40
    v_perm_b32 v42, v40, v40, s23
    v_perm_b32 v44, v40, v40, s22
    v_alignbit_b32 v41, v40, v40, 16
    v_mov_b32 v45, v44
    v_mov_b32 v46, v42
    v_cndmask_b32 v43, v42, v41, s[20:21]
    v_cndmask_b32 v47, v41, v44, s[20:21]
    ds_write_b64 v28, v[42:43] offset:0
    ds_write_b64 v28, v[44:45] offset:8
    ds_write_b64 v28, v[46:47] offset:4160
    ds_write_b64 v28, v[44:45] offset:4168
    s_branch KA_RX
KA_R1:
    v_lshlrev_b32 v28, 4, v2
    v_add_u32 v28, s39, v28
    s_mov_b32 s22, 0x01000100
    s_mov_b32 s23, 0x03020302
    v_lshlrev_b32 v26, 1, v2
    v_sub_u32 v26, 1150, v26
    v_add_u32 v26, s40, v26
    ds_read_u16 v40, v26
    ds_read_u16 v41, v26 offset:2
    v_and_b32 v16, 1, v2
    v_cmp_eq_u32 s[20:21], 1, v16
    s_waitcnt lgkmcnt(0)
    v_lshl_or_b32 v40, v41, 16, v40
    v_perm_b32 v42, v40, v40, s23
    v_perm_b32 v44, v40, v40, s22
    v_alignbit_b32 v41, v40, v40, 16
    v_mov_b32 v45, v44
    v_mov_b32 v46, v42
    v_cndmask_b32 v43, v42, v41, s[20:21]
    v_cndmask_b32 v47, v41, v44, s[20:21]
    ds_write_b64 v28, v[42:43] offset:1024
    ds_write_b64 v28, v[44:45] offset:1032
    ds_write_b64 v28, v[46:47] offset:5184
    ds_write_b64 v28, v[44:45] offset:5192
KA_RX:
    s_waitcnt lgkmcnt(0)
    s_lshl_b32 s12, s37, 2
    s_add_u32 s12, s12, 135536
    v_mov_b32 v18, s12
    v_mov_b32 v19, 1
    s_mov_b64 exec, 1
    ds_add_u32 v18, v19
    s_mov_b64 exec, -1
    s_endpgm
KA_CONV:
    s_lshl_b32 s4, s35, 2
    s_add_u32 s4, s4, s3
    s_lshr_b32 s14, s4, 1
    s_lshl_b32 s14, s14, 2
    s_mul_i32 s39, s3, 27712
    s_mul_i32 s40, s3, 1600
    s_add_u32 s40, s40, 129024
    s_mul_i32 s41, s3, 4608
    s_add_u32 s41, s41, 110592
    v_and_b32 v6, 15, v2
    v_lshrrev_b32 v7, 4, v2
    v_lshrrev_b32 v8, 1, v7
    v_and_b32 v9, 1, v7
    v_mov_b32 v12, 0
    v_mov_b32 v13, 0
    v_lshlrev_b32 v14, 3, v2
    v_add_u32 v14, s41, v14
    ds_write_b64 v14, v[12:13]
    v_sub_u32 v14, 2047, v6
    v_lshlrev_b32 v15, 4, v8
    v_sub_u32 v14, v14, v15
    v_lshlrev_b32 v15, 3, v9
    v_add_u32 v14, v14, v15
    v_lshlrev_b32 v14, 1, v14
    v_add_u32 v15, 4158, v14
    v_and_b32 v16, 1, v6
    v_cmp_eq_u32 vcc, 1, v16
    s_nop 1
    v_cndmask_b32 v14, v15, v14, vcc
    v_add_u32 v14, s39, v14
    v_subrev_u32 v20, 960, v14
    v_subrev_u32 v21, 1984, v14
    v_subrev_u32 v22, 3008, v14
    v_subrev_u32 v23, 4032, v14
    v_lshlrev_b32 v15, 5, v6
    v_lshlrev_b32 v16, 5, v8
    v_sub_u32 v15, v15, v16
    v_lshlrev_b32 v16, 4, v9
    v_add_u32 v15, v15, v16
    v_add_u32 v15, 64, v15
    v_add_u32 v24, s41, v15
    v_lshlrev_b32 v15, 5, v6
    v_lshlrev_b32 v16, 3, v7
    v_add_u32 v25, v15, v16
    v_lshlrev_b32 v3, 3, v2
    v_sub_u32 v3, 511, v3
    v_subrev_u32 v30, 0, v3
    v_subrev_u32 v31, 1, v3
    v_subrev_u32 v32, 2, v3
    v_subrev_u32 v33, 3, v3
    v_subrev_u32 v34, 4, v3
    v_subrev_u32 v35, 5, v3
    v_subrev_u32 v36, 6, v3
    v_subrev_u32 v37, 7, v3
    v_subrev_u32 v38, 8, v3
    v_max_i32 v38, 0, v38
    v_cvt_f32_i32 v40, v30
    v_cvt_f32_i32 v41, v31
    v_cvt_f32_i32 v42, v32
    v_cvt_f32_i32 v43, v33
    v_cvt_f32_i32 v44, v34
    v_cvt_f32_i32 v45, v35
    v_cvt_f32_i32 v46, v36
    v_cvt_f32_i32 v47, v37
    v_cvt_f32_i32 v48, v38
    v_cvt_pk_bf16_f32 v50, v40, v41
    v_lshrrev_b32 v51, 16, v50
    v_and_b32 v50, 0xffff, v50
    v_cvt_pk_bf16_f32 v52, v42, v43
    v_lshrrev_b32 v53, 16, v52
    v_and_b32 v52, 0xffff, v52
    v_cvt_pk_bf16_f32 v54, v44, v45
    v_lshrrev_b32 v55, 16, v54
    v_and_b32 v54, 0xffff, v54
    v_cvt_pk_bf16_f32 v56, v46, v47
    v_lshrrev_b32 v57, 16, v56
    v_and_b32 v56, 0xffff, v56
    v_cvt_pk_bf16_f32 v58, v48, v48
    v_and_b32 v58, 0xffff, v58
    v_subrev_u32 v50, 17024, v50
    v_min_i32 v30, 127, v30
    v_max_i32 v50, v50, v30
    v_lshlrev_b32 v30, 1, v50
    v_add_u32 v30, s40, v30
    v_subrev_u32 v51, 17024, v51
    v_min_i32 v31, 127, v31
    v_max_i32 v51, v51, v31
    v_lshlrev_b32 v31, 1, v51
    v_add_u32 v31, s40, v31
    v_subrev_u32 v52, 17024, v52
    v_min_i32 v32, 127, v32
    v_max_i32 v52, v52, v32
    v_lshlrev_b32 v32, 1, v52
    v_add_u32 v32, s40, v32
    v_subrev_u32 v53, 17024, v53
    v_min_i32 v33, 127, v33
    v_max_i32 v53, v53, v33
    v_lshlrev_b32 v33, 1, v53
    v_add_u32 v33, s40, v33
    v_subrev_u32 v54, 17024, v54
    v_min_i32 v34, 127, v34
    v_max_i32 v54, v54, v34
    v_lshlrev_b32 v34, 1, v54
    v_add_u32 v34, s40, v34
    v_subrev_u32 v55, 17024, v55
    v_min_i32 v35, 127, v35
    v_max_i32 v55, v55, v35
    v_lshlrev_b32 v35, 1, v55
    v_add_u32 v35, s40, v35
    v_subrev_u32 v56, 17024, v56
    v_min_i32 v36, 127, v36
    v_max_i32 v56, v56, v36
    v_lshlrev_b32 v36, 1, v56
    v_add_u32 v36, s40, v36
    v_subrev_u32 v57, 17024, v57
    v_min_i32 v37, 127, v37
    v_max_i32 v57, v57, v37
    v_lshlrev_b32 v37, 1, v57
    v_add_u32 v37, s40, v37
    v_subrev_u32 v58, 17024, v58
    v_min_i32 v38, 127, v38
    v_max_i32 v58, v58, v38
    v_lshlrev_b32 v38, 1, v58
    v_add_u32 v38, s40, v38
    v_lshrrev_b32 v5, 2, v2
    v_mul_u32_u24 v5, 10240, v5
    v_and_b32 v4, 3, v2
    v_lshl_add_u32 v5, v4, 4, v5
    s_lshl_b32 s7, s35, 6
    s_mul_i32 s8, s3, 655360
    s_add_u32 s7, s7, s8
    s_add_u32 s7, s7, 0
    v_add_u32 v5, s7, v5
    v_mul_u32_u24 v4, 4608, v4
    v_lshrrev_b32 v3, 2, v2
    v_lshl_add_u32 v4, v3, 4, v4
    s_lshl_b32 s8, s3, 10
    s_add_u32 s8, s8, 111104
    v_add_u32 v4, s8, v4
    s_load_dword s11, s[28:29], s14
    s_cmp_lg_u32 s3, 3
    s_cbranch_scc1 KA_GOT
    v_mov_b32 v18, 135500
    s_mov_b32 s12, 0
KA_OWN:
    ds_read_b32 v19, v18
    s_waitcnt lgkmcnt(0)
    v_readfirstlane_b32 s13, v19
    s_nop 0
    s_cmp_ge_u32 s13, 4
    s_cbranch_scc1 KA_OWN_OK
    s_add_u32 s12, s12, 1
    s_sleep 4
    s_cmp_lt_u32 s12, 4194304
    s_cbranch_scc1 KA_OWN
KA_OWN_OK:
    v_lshlrev_b32 v3, 7, v2
    v_add_u32 v3, 9633792, v3
    s_mov_b32 s12, 0
    s_sleep 24
KA_POLL:
    global_load_dwordx4 v[40:43], v3, s[32:33] sc1
    s_waitcnt vmcnt(0)
    v_cmp_ne_u32 vcc, s15, v40
    v_cmp_ne_u32 s[20:21], s15, v41
    v_cmp_ne_u32 s[22:23], s15, v42
    v_cmp_ne_u32 s[24:25], s15, v43
    s_or_b64 vcc, vcc, s[20:21]
    s_or_b64 s[22:23], s[22:23], s[24:25]
    s_or_b64 vcc, vcc, s[22:23]
    s_cmp_eq_u64 vcc, 0
    s_cbranch_scc1 KA_POLL_SEEN
    s_add_u32 s12, s12, 1
    s_cmp_ge_u32 s12, 65536
    s_cbranch_scc1 KA_POLL_SEEN
    s_sleep 6
    s_branch KA_POLL
KA_POLL_SEEN:
    s_cmp_lg_u32 s2, 96
    s_cbranch_scc1 KA_GOT
    v_mov_b32 v3, 9601024
    v_mov_b32 v10, s15
    s_mov_b64 exec, 1
    global_store_dword v3, v10, s[32:33] sc1
    s_mov_b64 exec, -1
KA_GOT:
    v_mov_b32 v96, 0
    v_mov_b32 v97, 0
    v_mov_b32 v98, 0
    v_mov_b32 v99, 0
    v_mov_b32 v100, 0
    v_mov_b32 v101, 0
    v_mov_b32 v102, 0
    v_mov_b32 v103, 0
    v_mov_b32 v104, 0
    v_mov_b32 v105, 0
    v_mov_b32 v106, 0
    v_mov_b32 v107, 0
    v_mov_b32 v108, 0
    v_mov_b32 v109, 0
    v_mov_b32 v110, 0
    v_mov_b32 v111, 0
    v_mov_b32 v112, 0
    v_mov_b32 v113, 0
    v_mov_b32 v114, 0
    v_mov_b32 v115, 0
    v_mov_b32 v116, 0
    v_mov_b32 v117, 0
    v_mov_b32 v118, 0
    v_mov_b32 v119, 0
    v_mov_b32 v120, 0
    v_mov_b32 v121, 0
    v_mov_b32 v122, 0
    v_mov_b32 v123, 0
    v_mov_b32 v124, 0
    v_mov_b32 v125, 0
    v_mov_b32 v126, 0
    v_mov_b32 v127, 0
    s_bitcmp1_b32 s4, 0
    s_waitcnt lgkmcnt(0)
    v_mov_b32 v18, 135496
    v_mov_b32 v19, 1
    s_mov_b64 exec, 1
    ds_add_u32 v18, v19
    s_mov_b64 exec, -1
    s_mov_b32 s12, 0
KA_GS2:
    ds_read_b32 v19, v18
    s_waitcnt lgkmcnt(0)
    v_readfirstlane_b32 s13, v19
    s_nop 0
    s_cmp_ge_u32 s13, 4
    s_cbranch_scc1 KA_GS2_OK
    s_add_u32 s12, s12, 1
    s_cmp_lt_u32 s12, 4194304
    s_cbranch_scc1 KA_GS2
KA_GS2_OK:
    global_load_dwordx4 v[64:67], v5, s[32:33] sc1
    v_add_u32 v5, 163840, v5
    global_load_dwordx4 v[68:71], v5, s[32:33] sc1
    v_add_u32 v5, 163840, v5
    global_load_dwordx4 v[72:75], v5, s[32:33] sc1
    v_add_u32 v5, 163840, v5
    global_load_dwordx4 v[76:79], v5, s[32:33] sc1
    s_bitcmp1_b32 s4, 0
    s_cbranch_scc1 KA_ODD2
    s_lshl_b32 s11, s11, 16
KA_ODD2:
    s_and_b32 s11, s11, 0xffff0000
    s_waitcnt vmcnt(3)
    ds_write_b128 v4, v[64:67] offset:0
    s_waitcnt vmcnt(2)
    ds_write_b128 v4, v[68:71] offset:256
    s_waitcnt vmcnt(1)
    ds_write_b128 v4, v[72:75] offset:512
    s_waitcnt vmcnt(0)
    ds_write_b128 v4, v[76:79] offset:768
    s_waitcnt lgkmcnt(0)
    v_mov_b32 v18, 135556
    v_mov_b32 v19, 1
    s_mov_b64 exec, 1
    ds_add_u32 v18, v19
    s_mov_b64 exec, -1
    s_lshl_b32 s12, s3, 2
    s_add_u32 s12, s12, 135520
    v_mov_b32 v18, s12
    s_mov_b32 s12, 0
KA_W5C:
    ds_read_b32 v19, v18
    s_waitcnt lgkmcnt(0)
    v_readfirstlane_b32 s13, v19
    s_nop 0
    s_cmp_ge_u32 s13, 3
    s_cbranch_scc1 KA_W5C_OK
    s_add_u32 s12, s12, 1
    s_sleep 1
    s_cmp_lt_u32 s12, 4194304
    s_cbranch_scc1 KA_W5C
KA_W5C_OK:
    v_lshlrev_b32 v28, 4, v2
    v_add_u32 v28, s39, v28
    s_mov_b32 s22, 0x01000100
    s_mov_b32 s23, 0x03020302
    ds_read_u16 v40, v30
    ds_read_u16 v41, v31
    ds_read_u16 v42, v32
    ds_read_u16 v43, v33
    ds_read_u16 v44, v34
    ds_read_u16 v45, v35
    ds_read_u16 v46, v36
    ds_read_u16 v47, v37
    ds_read_u16 v48, v38
    v_mov_b32 v12, 0
    v_and_b32 v14, 15, v2
    v_lshlrev_b32 v14, 2, v14
    v_add_u32 v14, s39, v14
    ds_write_b32 v14, v12 offset:4096
    ds_write_b32 v14, v12 offset:8256
    s_waitcnt lgkmcnt(2)
    v_lshl_or_b32 v52, v41, 16, v40
    v_lshl_or_b32 v53, v43, 16, v42
    v_lshl_or_b32 v54, v45, 16, v44
    v_lshl_or_b32 v55, v47, 16, v46
    v_alignbit_b32 v56, v53, v52, 16
    v_alignbit_b32 v57, v54, v53, 16
    v_alignbit_b32 v58, v55, v54, 16
    v_alignbit_b32 v59, v48, v55, 16
    ds_write_b128 v28, v[52:55] offset:3072
    ds_write_b128 v28, v[56:59] offset:7232
    v_mov_b32 v14, s39
    ds_write_b16 v14, v12 offset:8254
    s_lshl_b32 s12, s3, 2
    s_add_u32 s12, s12, 135424
    v_mov_b32 v3, s12
    ds_read_b32 v10, v3
    s_lshl_b32 s12, s3, 2
    s_add_u32 s12, s12, 135536
    v_mov_b32 v18, s12
    s_mov_b32 s12, 0
KA_W6:
    ds_read_b32 v19, v18
    s_waitcnt lgkmcnt(0)
    v_readfirstlane_b32 s13, v19
    s_nop 0
    s_cmp_ge_u32 s13, 3
    s_cbranch_scc1 KA_W6_OK
    s_add_u32 s12, s12, 1
    s_sleep 1
    s_cmp_lt_u32 s12, 4194304
    s_cbranch_scc1 KA_W6
KA_W6_OK:
    v_mov_b32 v18, 135556
    s_mov_b32 s12, 0
KA_W7:
    ds_read_b32 v19, v18
    s_waitcnt lgkmcnt(0)
    v_readfirstlane_b32 s13, v19
    s_nop 0
    s_cmp_ge_u32 s13, 4
    s_cbranch_scc1 KA_W7_OK
    s_add_u32 s12, s12, 1
    s_cmp_lt_u32 s12, 4194304
    s_cbranch_scc1 KA_W7
KA_W7_OK:
    ds_read_b128 v[92:95], v24 offset:4032
    ds_read2_b32 v[32:33], v20 offset0:240 offset1:241
    ds_read2_b32 v[34:35], v20 offset0:242 offset1:243
    ds_read_b128 v[88:91], v24 offset:3520
    ds_read_b128 v[84:87], v24 offset:3008
    ds_read_b128 v[80:83], v24 offset:2496
    ds_read_b128 v[76:79], v24 offset:1984
    ds_read_b128 v[72:75], v24 offset:1472
    ds_read_b128 v[68:71], v24 offset:960
    ds_read_b128 v[64:67], v24 offset:448
    ds_read2_b32 v[36:37], v20 offset0:112 offset1:113
    ds_read2_b32 v[38:39], v20 offset0:114 offset1:115
    ds_read2_b32 v[40:41], v21 offset0:240 offset1:241
    ds_read2_b32 v[42:43], v21 offset0:242 offset1:243
    ds_read2_b32 v[44:45], v21 offset0:112 offset1:113
    ds_read2_b32 v[46:47], v21 offset0:114 offset1:115
    ds_read2_b32 v[48:49], v22 offset0:240 offset1:241
    ds_read2_b32 v[50:51], v22 offset0:242 offset1:243
    ds_read2_b32 v[52:53], v22 offset0:112 offset1:113
    ds_read2_b32 v[54:55], v22 offset0:114 offset1:115
    ds_read2_b32 v[56:57], v23 offset0:240 offset1:241
    ds_read2_b32 v[58:59], v23 offset0:242 offset1:243
    ds_read2_b32 v[60:61], v23 offset0:112 offset1:113
    ds_read2_b32 v[62:63], v23 offset0:114 offset1:115
    s_waitcnt lgkmcnt(15)
    v_mfma_f32_16x16x32_f16 v[124:127], v[32:35], v[92:95], v[124:127]
    ds_read_b128 v[92:95], v24 offset:3968
    s_waitcnt lgkmcnt(15)
    v_mfma_f32_16x16x32_f16 v[120:123], v[32:35], v[88:91], v[120:123]
    s_waitcnt lgkmcnt(15)
    v_mfma_f32_16x16x32_f16 v[116:119], v[32:35], v[84:87], v[116:119]
    s_waitcnt lgkmcnt(15)
    v_mfma_f32_16x16x32_f16 v[112:115], v[32:35], v[80:83], v[112:115]
    s_waitcnt lgkmcnt(15)
    v_mfma_f32_16x16x32_f16 v[108:111], v[32:35], v[76:79], v[108:111]
    s_waitcnt lgkmcnt(15)
    v_mfma_f32_16x16x32_f16 v[104:107], v[32:35], v[72:75], v[104:107]
    s_waitcnt lgkmcnt(15)
    v_mfma_f32_16x16x32_f16 v[100:103], v[32:35], v[68:71], v[100:103]
    s_waitcnt lgkmcnt(15)
    v_mfma_f32_16x16x32_f16 v[96:99], v[32:35], v[64:67], v[96:99]
    ds_read2_b32 v[32:33], v20 offset0:224 offset1:225
    s_waitcnt lgkmcnt(14)
    v_mfma_f32_16x16x32_f16 v[124:127], v[36:39], v[88:91], v[124:127]
    ds_read_b128 v[88:91], v24 offset:3456
    v_mfma_f32_16x16x32_f16 v[120:123], v[36:39], v[84:87], v[120:123]
    ds_read2_b32 v[34:35], v20 offset0:226 offset1:227
    v_mfma_f32_16x16x32_f16 v[116:119], v[36:39], v[80:83], v[116:119]
    v_mfma_f32_16x16x32_f16 v[112:115], v[36:39], v[76:79], v[112:115]
    v_mfma_f32_16x16x32_f16 v[108:111], v[36:39], v[72:75], v[108:111]
    v_mfma_f32_16x16x32_f16 v[104:107], v[36:39], v[68:71], v[104:107]
    v_mfma_f32_16x16x32_f16 v[100:103], v[36:39], v[64:67], v[100:103]
    ds_read2_b32 v[36:37], v20 offset0:96 offset1:97
    s_waitcnt lgkmcnt(15)
    v_mfma_f32_16x16x32_f16 v[124:127], v[40:43], v[84:87], v[124:127]
    ds_read_b128 v[84:87], v24 offset:2944
    v_mfma_f32_16x16x32_f16 v[120:123], v[40:43], v[80:83], v[120:123]
    ds_read2_b32 v[38:39], v20 offset0:98 offset1:99
    v_mfma_f32_16x16x32_f16 v[116:119], v[40:43], v[76:79], v[116:119]
    v_mfma_f32_16x16x32_f16 v[112:115], v[40:43], v[72:75], v[112:115]
    v_mfma_f32_16x16x32_f16 v[108:111], v[40:43], v[68:71], v[108:111]
    v_mfma_f32_16x16x32_f16 v[104:107], v[40:43], v[64:67], v[104:107]
    ds_read2_b32 v[40:41], v21 offset0:224 offset1:225
    s_waitcnt lgkmcnt(15)
    v_mfma_f32_16x16x32_f16 v[124:127], v[44:47], v[80:83], v[124:127]
    ds_read_b128 v[80:83], v24 offset:2432
    v_mfma_f32_16x16x32_f16 v[120:123], v[44:47], v[76:79], v[120:123]
    ds_read2_b32 v[42:43], v21 offset0:226 offset1:227
    v_mfma_f32_16x16x32_f16 v[116:119], v[44:47], v[72:75], v[116:119]
    v_mfma_f32_16x16x32_f16 v[112:115], v[44:47], v[68:71], v[112:115]
    v_mfma_f32_16x16x32_f16 v[108:111], v[44:47], v[64:67], v[108:111]
    ds_read2_b32 v[44:45], v21 offset0:96 offset1:97
    s_waitcnt lgkmcnt(15)
    v_mfma_f32_16x16x32_f16 v[124:127], v[48:51], v[76:79], v[124:127]
    ds_read_b128 v[76:79], v24 offset:1920
    v_mfma_f32_16x16x32_f16 v[120:123], v[48:51], v[72:75], v[120:123]
    ds_read2_b32 v[46:47], v21 offset0:98 offset1:99
    v_mfma_f32_16x16x32_f16 v[116:119], v[48:51], v[68:71], v[116:119]
    v_mfma_f32_16x16x32_f16 v[112:115], v[48:51], v[64:67], v[112:115]
    ds_read2_b32 v[48:49], v22 offset0:224 offset1:225
    s_waitcnt lgkmcnt(15)
    v_mfma_f32_16x16x32_f16 v[124:127], v[52:55], v[72:75], v[124:127]
    ds_read_b128 v[72:75], v24 offset:1408
    v_mfma_f32_16x16x32_f16 v[120:123], v[52:55], v[68:71], v[120:123]
    ds_read2_b32 v[50:51], v22 offset0:226 offset1:227
    v_mfma_f32_16x16x32_f16 v[116:119], v[52:55], v[64:67], v[116:119]
    ds_read2_b32 v[52:53], v22 offset0:96 offset1:97
    s_waitcnt lgkmcnt(15)
    v_mfma_f32_16x16x32_f16 v[124:127], v[56:59], v[68:71], v[124:127]
    ds_read_b128 v[68:71], v24 offset:896
    v_mfma_f32_16x16x32_f16 v[120:123], v[56:59], v[64:67], v[120:123]
    ds_read2_b32 v[54:55], v22 offset0:98 offset1:99
    s_waitcnt lgkmcnt(15)
    v_mfma_f32_16x16x32_f16 v[124:127], v[60:63], v[64:67], v[124:127]
    ds_read_b128 v[64:67], v24 offset:384
    s_waitcnt lgkmcnt(15)
    v_mfma_f32_16x16x32_f16 v[124:127], v[32:35], v[92:95], v[124:127]
    ds_read_b128 v[92:95], v24 offset:3904
    v_mfma_f32_16x16x32_f16 v[120:123], v[32:35], v[88:91], v[120:123]
    ds_read2_b32 v[56:57], v23 offset0:224 offset1:225
    s_waitcnt lgkmcnt(15)
    v_mfma_f32_16x16x32_f16 v[116:119], v[32:35], v[84:87], v[116:119]
    ds_read2_b32 v[58:59], v23 offset0:226 offset1:227
    s_waitcnt lgkmcnt(14)
    v_mfma_f32_16x16x32_f16 v[112:115], v[32:35], v[80:83], v[112:115]
    ds_read2_b32 v[60:61], v23 offset0:96 offset1:97
    s_waitcnt lgkmcnt(12)
    v_mfma_f32_16x16x32_f16 v[108:111], v[32:35], v[76:79], v[108:111]
    ds_read2_b32 v[62:63], v23 offset0:98 offset1:99
    s_waitcnt lgkmcnt(10)
    v_mfma_f32_16x16x32_f16 v[104:107], v[32:35], v[72:75], v[104:107]
    s_waitcnt lgkmcnt(7)
    v_mfma_f32_16x16x32_f16 v[100:103], v[32:35], v[68:71], v[100:103]
    s_waitcnt lgkmcnt(5)
    v_mfma_f32_16x16x32_f16 v[96:99], v[32:35], v[64:67], v[96:99]
    ds_read2_b32 v[32:33], v20 offset0:208 offset1:209
    v_mfma_f32_16x16x32_f16 v[124:127], v[36:39], v[88:91], v[124:127]
    ds_read_b128 v[88:91], v24 offset:3392
    v_mfma_f32_16x16x32_f16 v[120:123], v[36:39], v[84:87], v[120:123]
    ds_read2_b32 v[34:35], v20 offset0:210 offset1:211
    v_mfma_f32_16x16x32_f16 v[116:119], v[36:39], v[80:83], v[116:119]
    v_mfma_f32_16x16x32_f16 v[112:115], v[36:39], v[76:79], v[112:115]
    v_mfma_f32_16x16x32_f16 v[108:111], v[36:39], v[72:75], v[108:111]
    v_mfma_f32_16x16x32_f16 v[104:107], v[36:39], v[68:71], v[104:107]
    v_mfma_f32_16x16x32_f16 v[100:103], v[36:39], v[64:67], v[100:103]
    ds_read2_b32 v[36:37], v20 offset0:80 offset1:81
    v_mfma_f32_16x16x32_f16 v[124:127], v[40:43], v[84:87], v[124:127]
    ds_read_b128 v[84:87], v24 offset:2880
    v_mfma_f32_16x16x32_f16 v[120:123], v[40:43], v[80:83], v[120:123]
    ds_read2_b32 v[38:39], v20 offset0:82 offset1:83
    v_mfma_f32_16x16x32_f16 v[116:119], v[40:43], v[76:79], v[116:119]
    v_mfma_f32_16x16x32_f16 v[112:115], v[40:43], v[72:75], v[112:115]
    v_mfma_f32_16x16x32_f16 v[108:111], v[40:43], v[68:71], v[108:111]
    v_mfma_f32_16x16x32_f16 v[104:107], v[40:43], v[64:67], v[104:107]
    ds_read2_b32 v[40:41], v21 offset0:208 offset1:209
    v_mfma_f32_16x16x32_f16 v[124:127], v[44:47], v[80:83], v[124:127]
    ds_read_b128 v[80:83], v24 offset:2368
    v_mfma_f32_16x16x32_f16 v[120:123], v[44:47], v[76:79], v[120:123]
    ds_read2_b32 v[42:43], v21 offset0:210 offset1:211
    v_mfma_f32_16x16x32_f16 v[116:119], v[44:47], v[72:75], v[116:119]
    v_mfma_f32_16x16x32_f16 v[112:115], v[44:47], v[68:71], v[112:115]
    v_mfma_f32_16x16x32_f16 v[108:111], v[44:47], v[64:67], v[108:111]
    ds_read2_b32 v[44:45], v21 offset0:80 offset1:81
    v_mfma_f32_16x16x32_f16 v[124:127], v[48:51], v[76:79], v[124:127]
    ds_read_b128 v[76:79], v24 offset:1856
    v_mfma_f32_16x16x32_f16 v[120:123], v[48:51], v[72:75], v[120:123]
    ds_read2_b32 v[46:47], v21 offset0:82 offset1:83
    v_mfma_f32_16x16x32_f16 v[116:119], v[48:51], v[68:71], v[116:119]
    v_mfma_f32_16x16x32_f16 v[112:115], v[48:51], v[64:67], v[112:115]
    ds_read2_b32 v[48:49], v22 offset0:208 offset1:209
    v_mfma_f32_16x16x32_f16 v[124:127], v[52:55], v[72:75], v[124:127]
    ds_read_b128 v[72:75], v24 offset:1344
    v_mfma_f32_16x16x32_f16 v[120:123], v[52:55], v[68:71], v[120:123]
    ds_read2_b32 v[50:51], v22 offset0:210 offset1:211
    v_mfma_f32_16x16x32_f16 v[116:119], v[52:55], v[64:67], v[116:119]
    ds_read2_b32 v[52:53], v22 offset0:80 offset1:81
    s_waitcnt lgkmcnt(15)
    v_mfma_f32_16x16x32_f16 v[124:127], v[56:59], v[68:71], v[124:127]
    ds_read_b128 v[68:71], v24 offset:832
    v_mfma_f32_16x16x32_f16 v[120:123], v[56:59], v[64:67], v[120:123]
    ds_read2_b32 v[54:55], v22 offset0:82 offset1:83
    s_waitcnt lgkmcnt(15)
    v_mfma_f32_16x16x32_f16 v[124:127], v[60:63], v[64:67], v[124:127]
    ds_read_b128 v[64:67], v24 offset:320
    s_waitcnt lgkmcnt(15)
    v_mfma_f32_16x16x32_f16 v[124:127], v[32:35], v[92:95], v[124:127]
    ds_read_b128 v[92:95], v24 offset:3840
    v_mfma_f32_16x16x32_f16 v[120:123], v[32:35], v[88:91], v[120:123]
    ds_read2_b32 v[56:57], v23 offset0:208 offset1:209
    s_waitcnt lgkmcnt(15)
    v_mfma_f32_16x16x32_f16 v[116:119], v[32:35], v[84:87], v[116:119]
    ds_read2_b32 v[58:59], v23 offset0:210 offset1:211
    s_waitcnt lgkmcnt(14)
    v_mfma_f32_16x16x32_f16 v[112:115], v[32:35], v[80:83], v[112:115]
    ds_read2_b32 v[60:61], v23 offset0:80 offset1:81
    s_waitcnt lgkmcnt(12)
    v_mfma_f32_16x16x32_f16 v[108:111], v[32:35], v[76:79], v[108:111]
    ds_read2_b32 v[62:63], v23 offset0:82 offset1:83
    s_waitcnt lgkmcnt(10)
    v_mfma_f32_16x16x32_f16 v[104:107], v[32:35], v[72:75], v[104:107]
    s_waitcnt lgkmcnt(7)
    v_mfma_f32_16x16x32_f16 v[100:103], v[32:35], v[68:71], v[100:103]
    s_waitcnt lgkmcnt(5)
    v_mfma_f32_16x16x32_f16 v[96:99], v[32:35], v[64:67], v[96:99]
    ds_read2_b32 v[32:33], v20 offset0:192 offset1:193
    v_mfma_f32_16x16x32_f16 v[124:127], v[36:39], v[88:91], v[124:127]
    ds_read_b128 v[88:91], v24 offset:3328
    v_mfma_f32_16x16x32_f16 v[120:123], v[36:39], v[84:87], v[120:123]
    ds_read2_b32 v[34:35], v20 offset0:194 offset1:195
    v_mfma_f32_16x16x32_f16 v[116:119], v[36:39], v[80:83], v[116:119]
    v_mfma_f32_16x16x32_f16 v[112:115], v[36:39], v[76:79], v[112:115]
    v_mfma_f32_16x16x32_f16 v[108:111], v[36:39], v[72:75], v[108:111]
    v_mfma_f32_16x16x32_f16 v[104:107], v[36:39], v[68:71], v[104:107]
    v_mfma_f32_16x16x32_f16 v[100:103], v[36:39], v[64:67], v[100:103]
    ds_read2_b32 v[36:37], v20 offset0:64 offset1:65
    v_mfma_f32_16x16x32_f16 v[124:127], v[40:43], v[84:87], v[124:127]
    ds_read_b128 v[84:87], v24 offset:2816
    v_mfma_f32_16x16x32_f16 v[120:123], v[40:43], v[80:83], v[120:123]
    ds_read2_b32 v[38:39], v20 offset0:66 offset1:67
    v_mfma_f32_16x16x32_f16 v[116:119], v[40:43], v[76:79], v[116:119]
    v_mfma_f32_16x16x32_f16 v[112:115], v[40:43], v[72:75], v[112:115]
    v_mfma_f32_16x16x32_f16 v[108:111], v[40:43], v[68:71], v[108:111]
    v_mfma_f32_16x16x32_f16 v[104:107], v[40:43], v[64:67], v[104:107]
    ds_read2_b32 v[40:41], v21 offset0:192 offset1:193
    v_mfma_f32_16x16x32_f16 v[124:127], v[44:47], v[80:83], v[124:127]
    ds_read_b128 v[80:83], v24 offset:2304
    v_mfma_f32_16x16x32_f16 v[120:123], v[44:47], v[76:79], v[120:123]
    ds_read2_b32 v[42:43], v21 offset0:194 offset1:195
    v_mfma_f32_16x16x32_f16 v[116:119], v[44:47], v[72:75], v[116:119]
    v_mfma_f32_16x16x32_f16 v[112:115], v[44:47], v[68:71], v[112:115]
    v_mfma_f32_16x16x32_f16 v[108:111], v[44:47], v[64:67], v[108:111]
    ds_read2_b32 v[44:45], v21 offset0:64 offset1:65
    v_mfma_f32_16x16x32_f16 v[124:127], v[48:51], v[76:79], v[124:127]
    ds_read_b128 v[76:79], v24 offset:1792
    v_mfma_f32_16x16x32_f16 v[120:123], v[48:51], v[72:75], v[120:123]
    ds_read2_b32 v[46:47], v21 offset0:66 offset1:67
    v_mfma_f32_16x16x32_f16 v[116:119], v[48:51], v[68:71], v[116:119]
    v_mfma_f32_16x16x32_f16 v[112:115], v[48:51], v[64:67], v[112:115]
    ds_read2_b32 v[48:49], v22 offset0:192 offset1:193
    v_mfma_f32_16x16x32_f16 v[124:127], v[52:55], v[72:75], v[124:127]
    ds_read_b128 v[72:75], v24 offset:1280
    v_mfma_f32_16x16x32_f16 v[120:123], v[52:55], v[68:71], v[120:123]
    ds_read2_b32 v[50:51], v22 offset0:194 offset1:195
    v_mfma_f32_16x16x32_f16 v[116:119], v[52:55], v[64:67], v[116:119]
    ds_read2_b32 v[52:53], v22 offset0:64 offset1:65
    s_waitcnt lgkmcnt(15)
    v_mfma_f32_16x16x32_f16 v[124:127], v[56:59], v[68:71], v[124:127]
    ds_read_b128 v[68:71], v24 offset:768
    v_mfma_f32_16x16x32_f16 v[120:123], v[56:59], v[64:67], v[120:123]
    ds_read2_b32 v[54:55], v22 offset0:66 offset1:67
    s_waitcnt lgkmcnt(15)
    v_mfma_f32_16x16x32_f16 v[124:127], v[60:63], v[64:67], v[124:127]
    ds_read_b128 v[64:67], v24 offset:256
    s_waitcnt lgkmcnt(15)
    v_mfma_f32_16x16x32_f16 v[124:127], v[32:35], v[92:95], v[124:127]
    ds_read_b128 v[92:95], v24 offset:3776
    v_mfma_f32_16x16x32_f16 v[120:123], v[32:35], v[88:91], v[120:123]
    ds_read2_b32 v[56:57], v23 offset0:192 offset1:193
    s_waitcnt lgkmcnt(15)
    v_mfma_f32_16x16x32_f16 v[116:119], v[32:35], v[84:87], v[116:119]
    ds_read2_b32 v[58:59], v23 offset0:194 offset1:195
    s_waitcnt lgkmcnt(14)
    v_mfma_f32_16x16x32_f16 v[112:115], v[32:35], v[80:83], v[112:115]
    ds_read2_b32 v[60:61], v23 offset0:64 offset1:65
    s_waitcnt lgkmcnt(12)
    v_mfma_f32_16x16x32_f16 v[108:111], v[32:35], v[76:79], v[108:111]
    ds_read2_b32 v[62:63], v23 offset0:66 offset1:67
    s_waitcnt lgkmcnt(10)
    v_mfma_f32_16x16x32_f16 v[104:107], v[32:35], v[72:75], v[104:107]
    s_waitcnt lgkmcnt(7)
    v_mfma_f32_16x16x32_f16 v[100:103], v[32:35], v[68:71], v[100:103]
    s_waitcnt lgkmcnt(5)
    v_mfma_f32_16x16x32_f16 v[96:99], v[32:35], v[64:67], v[96:99]
    ds_read2_b32 v[32:33], v20 offset0:176 offset1:177
    v_mfma_f32_16x16x32_f16 v[124:127], v[36:39], v[88:91], v[124:127]
    ds_read_b128 v[88:91], v24 offset:3264
    v_mfma_f32_16x16x32_f16 v[120:123], v[36:39], v[84:87], v[120:123]
    ds_read2_b32 v[34:35], v20 offset0:178 offset1:179
    v_mfma_f32_16x16x32_f16 v[116:119], v[36:39], v[80:83], v[116:119]
    v_mfma_f32_16x16x32_f16 v[112:115], v[36:39], v[76:79], v[112:115]
    v_mfma_f32_16x16x32_f16 v[108:111], v[36:39], v[72:75], v[108:111]
    v_mfma_f32_16x16x32_f16 v[104:107], v[36:39], v[68:71], v[104:107]
    v_mfma_f32_16x16x32_f16 v[100:103], v[36:39], v[64:67], v[100:103]
    ds_read2_b32 v[36:37], v20 offset0:48 offset1:49
    v_mfma_f32_16x16x32_f16 v[124:127], v[40:43], v[84:87], v[124:127]
    ds_read_b128 v[84:87], v24 offset:2752
    v_mfma_f32_16x16x32_f16 v[120:123], v[40:43], v[80:83], v[120:123]
    ds_read2_b32 v[38:39], v20 offset0:50 offset1:51
    v_mfma_f32_16x16x32_f16 v[116:119], v[40:43], v[76:79], v[116:119]
    v_mfma_f32_16x16x32_f16 v[112:115], v[40:43], v[72:75], v[112:115]
    v_mfma_f32_16x16x32_f16 v[108:111], v[40:43], v[68:71], v[108:111]
    v_mfma_f32_16x16x32_f16 v[104:107], v[40:43], v[64:67], v[104:107]
    ds_read2_b32 v[40:41], v21 offset0:176 offset1:177
    v_mfma_f32_16x16x32_f16 v[124:127], v[44:47], v[80:83], v[124:127]
    ds_read_b128 v[80:83], v24 offset:2240
    v_mfma_f32_16x16x32_f16 v[120:123], v[44:47], v[76:79], v[120:123]
    ds_read2_b32 v[42:43], v21 offset0:178 offset1:179
    v_mfma_f32_16x16x32_f16 v[116:119], v[44:47], v[72:75], v[116:119]
    v_mfma_f32_16x16x32_f16 v[112:115], v[44:47], v[68:71], v[112:115]
    v_mfma_f32_16x16x32_f16 v[108:111], v[44:47], v[64:67], v[108:111]
    ds_read2_b32 v[44:45], v21 offset0:48 offset1:49
    v_mfma_f32_16x16x32_f16 v[124:127], v[48:51], v[76:79], v[124:127]
    ds_read_b128 v[76:79], v24 offset:1728
    v_mfma_f32_16x16x32_f16 v[120:123], v[48:51], v[72:75], v[120:123]
    ds_read2_b32 v[46:47], v21 offset0:50 offset1:51
    v_mfma_f32_16x16x32_f16 v[116:119], v[48:51], v[68:71], v[116:119]
    v_mfma_f32_16x16x32_f16 v[112:115], v[48:51], v[64:67], v[112:115]
    ds_read2_b32 v[48:49], v22 offset0:176 offset1:177
    v_mfma_f32_16x16x32_f16 v[124:127], v[52:55], v[72:75], v[124:127]
    ds_read_b128 v[72:75], v24 offset:1216
    v_mfma_f32_16x16x32_f16 v[120:123], v[52:55], v[68:71], v[120:123]
    ds_read2_b32 v[50:51], v22 offset0:178 offset1:179
    v_mfma_f32_16x16x32_f16 v[116:119], v[52:55], v[64:67], v[116:119]
    ds_read2_b32 v[52:53], v22 offset0:48 offset1:49
    s_waitcnt lgkmcnt(15)
    v_mfma_f32_16x16x32_f16 v[124:127], v[56:59], v[68:71], v[124:127]
    ds_read_b128 v[68:71], v24 offset:704
    v_mfma_f32_16x16x32_f16 v[120:123], v[56:59], v[64:67], v[120:123]
    ds_read2_b32 v[54:55], v22 offset0:50 offset1:51
    s_waitcnt lgkmcnt(15)
    v_mfma_f32_16x16x32_f16 v[124:127], v[60:63], v[64:67], v[124:127]
    ds_read_b128 v[64:67], v24 offset:192
    s_waitcnt lgkmcnt(15)
    v_mfma_f32_16x16x32_f16 v[124:127], v[32:35], v[92:95], v[124:127]
    ds_read_b128 v[92:95], v24 offset:3712
    v_mfma_f32_16x16x32_f16 v[120:123], v[32:35], v[88:91], v[120:123]
    ds_read2_b32 v[56:57], v23 offset0:176 offset1:177
    s_waitcnt lgkmcnt(15)
    v_mfma_f32_16x16x32_f16 v[116:119], v[32:35], v[84:87], v[116:119]
    ds_read2_b32 v[58:59], v23 offset0:178 offset1:179
    s_waitcnt lgkmcnt(14)
    v_mfma_f32_16x16x32_f16 v[112:115], v[32:35], v[80:83], v[112:115]
    ds_read2_b32 v[60:61], v23 offset0:48 offset1:49
    s_waitcnt lgkmcnt(12)
    v_mfma_f32_16x16x32_f16 v[108:111], v[32:35], v[76:79], v[108:111]
    ds_read2_b32 v[62:63], v23 offset0:50 offset1:51
    s_waitcnt lgkmcnt(10)
    v_mfma_f32_16x16x32_f16 v[104:107], v[32:35], v[72:75], v[104:107]
    s_waitcnt lgkmcnt(7)
    v_mfma_f32_16x16x32_f16 v[100:103], v[32:35], v[68:71], v[100:103]
    s_waitcnt lgkmcnt(5)
    v_mfma_f32_16x16x32_f16 v[96:99], v[32:35], v[64:67], v[96:99]
    ds_read2_b32 v[32:33], v20 offset0:160 offset1:161
    v_mfma_f32_16x16x32_f16 v[124:127], v[36:39], v[88:91], v[124:127]
    ds_read_b128 v[88:91], v24 offset:3200
    v_mfma_f32_16x16x32_f16 v[120:123], v[36:39], v[84:87], v[120:123]
    ds_read2_b32 v[34:35], v20 offset0:162 offset1:163
    v_mfma_f32_16x16x32_f16 v[116:119], v[36:39], v[80:83], v[116:119]
    v_mfma_f32_16x16x32_f16 v[112:115], v[36:39], v[76:79], v[112:115]
    v_mfma_f32_16x16x32_f16 v[108:111], v[36:39], v[72:75], v[108:111]
    v_mfma_f32_16x16x32_f16 v[104:107], v[36:39], v[68:71], v[104:107]
    v_mfma_f32_16x16x32_f16 v[100:103], v[36:39], v[64:67], v[100:103]
    ds_read2_b32 v[36:37], v20 offset0:32 offset1:33
    v_mfma_f32_16x16x32_f16 v[124:127], v[40:43], v[84:87], v[124:127]
    ds_read_b128 v[84:87], v24 offset:2688
    v_mfma_f32_16x16x32_f16 v[120:123], v[40:43], v[80:83], v[120:123]
    ds_read2_b32 v[38:39], v20 offset0:34 offset1:35
    v_mfma_f32_16x16x32_f16 v[116:119], v[40:43], v[76:79], v[116:119]
    v_mfma_f32_16x16x32_f16 v[112:115], v[40:43], v[72:75], v[112:115]
    v_mfma_f32_16x16x32_f16 v[108:111], v[40:43], v[68:71], v[108:111]
    v_mfma_f32_16x16x32_f16 v[104:107], v[40:43], v[64:67], v[104:107]
    ds_read2_b32 v[40:41], v21 offset0:160 offset1:161
    v_mfma_f32_16x16x32_f16 v[124:127], v[44:47], v[80:83], v[124:127]
    ds_read_b128 v[80:83], v24 offset:2176
    v_mfma_f32_16x16x32_f16 v[120:123], v[44:47], v[76:79], v[120:123]
    ds_read2_b32 v[42:43], v21 offset0:162 offset1:163
    v_mfma_f32_16x16x32_f16 v[116:119], v[44:47], v[72:75], v[116:119]
    v_mfma_f32_16x16x32_f16 v[112:115], v[44:47], v[68:71], v[112:115]
    v_mfma_f32_16x16x32_f16 v[108:111], v[44:47], v[64:67], v[108:111]
    ds_read2_b32 v[44:45], v21 offset0:32 offset1:33
    v_mfma_f32_16x16x32_f16 v[124:127], v[48:51], v[76:79], v[124:127]
    ds_read_b128 v[76:79], v24 offset:1664
    v_mfma_f32_16x16x32_f16 v[120:123], v[48:51], v[72:75], v[120:123]
    ds_read2_b32 v[46:47], v21 offset0:34 offset1:35
    v_mfma_f32_16x16x32_f16 v[116:119], v[48:51], v[68:71], v[116:119]
    v_mfma_f32_16x16x32_f16 v[112:115], v[48:51], v[64:67], v[112:115]
    ds_read2_b32 v[48:49], v22 offset0:160 offset1:161
    v_mfma_f32_16x16x32_f16 v[124:127], v[52:55], v[72:75], v[124:127]
    ds_read_b128 v[72:75], v24 offset:1152
    v_mfma_f32_16x16x32_f16 v[120:123], v[52:55], v[68:71], v[120:123]
    ds_read2_b32 v[50:51], v22 offset0:162 offset1:163
    v_mfma_f32_16x16x32_f16 v[116:119], v[52:55], v[64:67], v[116:119]
    ds_read2_b32 v[52:53], v22 offset0:32 offset1:33
    s_waitcnt lgkmcnt(15)
    v_mfma_f32_16x16x32_f16 v[124:127], v[56:59], v[68:71], v[124:127]
    ds_read_b128 v[68:71], v24 offset:640
    v_mfma_f32_16x16x32_f16 v[120:123], v[56:59], v[64:67], v[120:123]
    ds_read2_b32 v[54:55], v22 offset0:34 offset1:35
    s_waitcnt lgkmcnt(15)
    v_mfma_f32_16x16x32_f16 v[124:127], v[60:63], v[64:67], v[124:127]
    ds_read_b128 v[64:67], v24 offset:128
    s_waitcnt lgkmcnt(15)
    v_mfma_f32_16x16x32_f16 v[124:127], v[32:35], v[92:95], v[124:127]
    ds_read_b128 v[92:95], v24 offset:3648
    v_mfma_f32_16x16x32_f16 v[120:123], v[32:35], v[88:91], v[120:123]
    ds_read2_b32 v[56:57], v23 offset0:160 offset1:161
    s_waitcnt lgkmcnt(15)
    v_mfma_f32_16x16x32_f16 v[116:119], v[32:35], v[84:87], v[116:119]
    ds_read2_b32 v[58:59], v23 offset0:162 offset1:163
    s_waitcnt lgkmcnt(14)
    v_mfma_f32_16x16x32_f16 v[112:115], v[32:35], v[80:83], v[112:115]
    ds_read2_b32 v[60:61], v23 offset0:32 offset1:33
    s_waitcnt lgkmcnt(12)
    v_mfma_f32_16x16x32_f16 v[108:111], v[32:35], v[76:79], v[108:111]
    ds_read2_b32 v[62:63], v23 offset0:34 offset1:35
    s_waitcnt lgkmcnt(10)
    v_mfma_f32_16x16x32_f16 v[104:107], v[32:35], v[72:75], v[104:107]
    s_waitcnt lgkmcnt(7)
    v_mfma_f32_16x16x32_f16 v[100:103], v[32:35], v[68:71], v[100:103]
    s_waitcnt lgkmcnt(5)
    v_mfma_f32_16x16x32_f16 v[96:99], v[32:35], v[64:67], v[96:99]
    ds_read2_b32 v[32:33], v20 offset0:144 offset1:145
    v_mfma_f32_16x16x32_f16 v[124:127], v[36:39], v[88:91], v[124:127]
    ds_read_b128 v[88:91], v24 offset:3136
    v_mfma_f32_16x16x32_f16 v[120:123], v[36:39], v[84:87], v[120:123]
    ds_read2_b32 v[34:35], v20 offset0:146 offset1:147
    v_mfma_f32_16x16x32_f16 v[116:119], v[36:39], v[80:83], v[116:119]
    v_mfma_f32_16x16x32_f16 v[112:115], v[36:39], v[76:79], v[112:115]
    v_mfma_f32_16x16x32_f16 v[108:111], v[36:39], v[72:75], v[108:111]
    v_mfma_f32_16x16x32_f16 v[104:107], v[36:39], v[68:71], v[104:107]
    v_mfma_f32_16x16x32_f16 v[100:103], v[36:39], v[64:67], v[100:103]
    ds_read2_b32 v[36:37], v20 offset0:16 offset1:17
    v_mfma_f32_16x16x32_f16 v[124:127], v[40:43], v[84:87], v[124:127]
    ds_read_b128 v[84:87], v24 offset:2624
    v_mfma_f32_16x16x32_f16 v[120:123], v[40:43], v[80:83], v[120:123]
    ds_read2_b32 v[38:39], v20 offset0:18 offset1:19
    v_mfma_f32_16x16x32_f16 v[116:119], v[40:43], v[76:79], v[116:119]
    v_mfma_f32_16x16x32_f16 v[112:115], v[40:43], v[72:75], v[112:115]
    v_mfma_f32_16x16x32_f16 v[108:111], v[40:43], v[68:71], v[108:111]
    v_mfma_f32_16x16x32_f16 v[104:107], v[40:43], v[64:67], v[104:107]
    ds_read2_b32 v[40:41], v21 offset0:144 offset1:145
    v_mfma_f32_16x16x32_f16 v[124:127], v[44:47], v[80:83], v[124:127]
    ds_read_b128 v[80:83], v24 offset:2112
    v_mfma_f32_16x16x32_f16 v[120:123], v[44:47], v[76:79], v[120:123]
    ds_read2_b32 v[42:43], v21 offset0:146 offset1:147
    v_mfma_f32_16x16x32_f16 v[116:119], v[44:47], v[72:75], v[116:119]
    v_mfma_f32_16x16x32_f16 v[112:115], v[44:47], v[68:71], v[112:115]
    v_mfma_f32_16x16x32_f16 v[108:111], v[44:47], v[64:67], v[108:111]
    ds_read2_b32 v[44:45], v21 offset0:16 offset1:17
    v_mfma_f32_16x16x32_f16 v[124:127], v[48:51], v[76:79], v[124:127]
    ds_read_b128 v[76:79], v24 offset:1600
    v_mfma_f32_16x16x32_f16 v[120:123], v[48:51], v[72:75], v[120:123]
    ds_read2_b32 v[46:47], v21 offset0:18 offset1:19
    v_mfma_f32_16x16x32_f16 v[116:119], v[48:51], v[68:71], v[116:119]
    v_mfma_f32_16x16x32_f16 v[112:115], v[48:51], v[64:67], v[112:115]
    ds_read2_b32 v[48:49], v22 offset0:144 offset1:145
    v_mfma_f32_16x16x32_f16 v[124:127], v[52:55], v[72:75], v[124:127]
    ds_read_b128 v[72:75], v24 offset:1088
    v_mfma_f32_16x16x32_f16 v[120:123], v[52:55], v[68:71], v[120:123]
    ds_read2_b32 v[50:51], v22 offset0:146 offset1:147
    v_mfma_f32_16x16x32_f16 v[116:119], v[52:55], v[64:67], v[116:119]
    ds_read2_b32 v[52:53], v22 offset0:16 offset1:17
    s_waitcnt lgkmcnt(15)
    v_mfma_f32_16x16x32_f16 v[124:127], v[56:59], v[68:71], v[124:127]
    ds_read_b128 v[68:71], v24 offset:576
    v_mfma_f32_16x16x32_f16 v[120:123], v[56:59], v[64:67], v[120:123]
    ds_read2_b32 v[54:55], v22 offset0:18 offset1:19
    s_waitcnt lgkmcnt(15)
    v_mfma_f32_16x16x32_f16 v[124:127], v[60:63], v[64:67], v[124:127]
    ds_read_b128 v[64:67], v24 offset:64
    s_waitcnt lgkmcnt(15)
    v_mfma_f32_16x16x32_f16 v[124:127], v[32:35], v[92:95], v[124:127]
    ds_read_b128 v[92:95], v24 offset:3584
    v_mfma_f32_16x16x32_f16 v[120:123], v[32:35], v[88:91], v[120:123]
    ds_read2_b32 v[56:57], v23 offset0:144 offset1:145
    s_waitcnt lgkmcnt(15)
    v_mfma_f32_16x16x32_f16 v[116:119], v[32:35], v[84:87], v[116:119]
    ds_read2_b32 v[58:59], v23 offset0:146 offset1:147
    s_waitcnt lgkmcnt(14)
    v_mfma_f32_16x16x32_f16 v[112:115], v[32:35], v[80:83], v[112:115]
    ds_read2_b32 v[60:61], v23 offset0:16 offset1:17
    s_waitcnt lgkmcnt(12)
    v_mfma_f32_16x16x32_f16 v[108:111], v[32:35], v[76:79], v[108:111]
    ds_read2_b32 v[62:63], v23 offset0:18 offset1:19
    s_waitcnt lgkmcnt(10)
    v_mfma_f32_16x16x32_f16 v[104:107], v[32:35], v[72:75], v[104:107]
    s_waitcnt lgkmcnt(7)
    v_mfma_f32_16x16x32_f16 v[100:103], v[32:35], v[68:71], v[100:103]
    s_waitcnt lgkmcnt(5)
    v_mfma_f32_16x16x32_f16 v[96:99], v[32:35], v[64:67], v[96:99]
    ds_read2_b32 v[32:33], v20 offset0:128 offset1:129
    v_mfma_f32_16x16x32_f16 v[124:127], v[36:39], v[88:91], v[124:127]
    ds_read_b128 v[88:91], v24 offset:3072
    v_mfma_f32_16x16x32_f16 v[120:123], v[36:39], v[84:87], v[120:123]
    ds_read2_b32 v[34:35], v20 offset0:130 offset1:131
    v_mfma_f32_16x16x32_f16 v[116:119], v[36:39], v[80:83], v[116:119]
    v_mfma_f32_16x16x32_f16 v[112:115], v[36:39], v[76:79], v[112:115]
    v_mfma_f32_16x16x32_f16 v[108:111], v[36:39], v[72:75], v[108:111]
    v_mfma_f32_16x16x32_f16 v[104:107], v[36:39], v[68:71], v[104:107]
    v_mfma_f32_16x16x32_f16 v[100:103], v[36:39], v[64:67], v[100:103]
    ds_read2_b32 v[36:37], v20 offset0:0 offset1:1
    v_mfma_f32_16x16x32_f16 v[124:127], v[40:43], v[84:87], v[124:127]
    ds_read_b128 v[84:87], v24 offset:2560
    v_mfma_f32_16x16x32_f16 v[120:123], v[40:43], v[80:83], v[120:123]
    ds_read2_b32 v[38:39], v20 offset0:2 offset1:3
    v_mfma_f32_16x16x32_f16 v[116:119], v[40:43], v[76:79], v[116:119]
    v_mfma_f32_16x16x32_f16 v[112:115], v[40:43], v[72:75], v[112:115]
    v_mfma_f32_16x16x32_f16 v[108:111], v[40:43], v[68:71], v[108:111]
    v_mfma_f32_16x16x32_f16 v[104:107], v[40:43], v[64:67], v[104:107]
    ds_read2_b32 v[40:41], v21 offset0:128 offset1:129
    v_mfma_f32_16x16x32_f16 v[124:127], v[44:47], v[80:83], v[124:127]
    ds_read_b128 v[80:83], v24 offset:2048
    v_mfma_f32_16x16x32_f16 v[120:123], v[44:47], v[76:79], v[120:123]
    ds_read2_b32 v[42:43], v21 offset0:130 offset1:131
    v_mfma_f32_16x16x32_f16 v[116:119], v[44:47], v[72:75], v[116:119]
    v_mfma_f32_16x16x32_f16 v[112:115], v[44:47], v[68:71], v[112:115]
    v_mfma_f32_16x16x32_f16 v[108:111], v[44:47], v[64:67], v[108:111]
    ds_read2_b32 v[44:45], v21 offset0:0 offset1:1
    v_mfma_f32_16x16x32_f16 v[124:127], v[48:51], v[76:79], v[124:127]
    ds_read_b128 v[76:79], v24 offset:1536
    v_mfma_f32_16x16x32_f16 v[120:123], v[48:51], v[72:75], v[120:123]
    ds_read2_b32 v[46:47], v21 offset0:2 offset1:3
    v_mfma_f32_16x16x32_f16 v[116:119], v[48:51], v[68:71], v[116:119]
    v_mfma_f32_16x16x32_f16 v[112:115], v[48:51], v[64:67], v[112:115]
    ds_read2_b32 v[48:49], v22 offset0:128 offset1:129
    v_mfma_f32_16x16x32_f16 v[124:127], v[52:55], v[72:75], v[124:127]
    ds_read_b128 v[72:75], v24 offset:1024
    v_mfma_f32_16x16x32_f16 v[120:123], v[52:55], v[68:71], v[120:123]
    ds_read2_b32 v[50:51], v22 offset0:130 offset1:131
    v_mfma_f32_16x16x32_f16 v[116:119], v[52:55], v[64:67], v[116:119]
    ds_read2_b32 v[52:53], v22 offset0:0 offset1:1
    s_waitcnt lgkmcnt(15)
    v_mfma_f32_16x16x32_f16 v[124:127], v[56:59], v[68:71], v[124:127]
    ds_read_b128 v[68:71], v24 offset:512
    v_mfma_f32_16x16x32_f16 v[120:123], v[56:59], v[64:67], v[120:123]
    ds_read2_b32 v[54:55], v22 offset0:2 offset1:3
    s_waitcnt lgkmcnt(15)
    v_mfma_f32_16x16x32_f16 v[124:127], v[60:63], v[64:67], v[124:127]
    ds_read_b128 v[64:67], v24 offset:0
    s_waitcnt lgkmcnt(15)
    v_mfma_f32_16x16x32_f16 v[124:127], v[32:35], v[92:95], v[124:127]
    ds_read2_b32 v[56:57], v23 offset0:128 offset1:129
    v_mfma_f32_16x16x32_f16 v[120:123], v[32:35], v[88:91], v[120:123]
    ds_read2_b32 v[58:59], v23 offset0:130 offset1:131
    s_waitcnt lgkmcnt(15)
    v_mfma_f32_16x16x32_f16 v[116:119], v[32:35], v[84:87], v[116:119]
    ds_read2_b32 v[60:61], v23 offset0:0 offset1:1
    s_waitcnt lgkmcnt(14)
    v_mfma_f32_16x16x32_f16 v[112:115], v[32:35], v[80:83], v[112:115]
    ds_read2_b32 v[62:63], v23 offset0:2 offset1:3
    s_waitcnt lgkmcnt(12)
    v_mfma_f32_16x16x32_f16 v[108:111], v[32:35], v[76:79], v[108:111]
    s_waitcnt lgkmcnt(9)
    v_mfma_f32_16x16x32_f16 v[104:107], v[32:35], v[72:75], v[104:107]
    s_waitcnt lgkmcnt(6)
    v_mfma_f32_16x16x32_f16 v[100:103], v[32:35], v[68:71], v[100:103]
    s_waitcnt lgkmcnt(4)
    v_mfma_f32_16x16x32_f16 v[96:99], v[32:35], v[64:67], v[96:99]
    v_mfma_f32_16x16x32_f16 v[124:127], v[36:39], v[88:91], v[124:127]
    v_mfma_f32_16x16x32_f16 v[120:123], v[36:39], v[84:87], v[120:123]
    v_mfma_f32_16x16x32_f16 v[116:119], v[36:39], v[80:83], v[116:119]
    v_mfma_f32_16x16x32_f16 v[112:115], v[36:39], v[76:79], v[112:115]
    v_mfma_f32_16x16x32_f16 v[108:111], v[36:39], v[72:75], v[108:111]
    v_mfma_f32_16x16x32_f16 v[104:107], v[36:39], v[68:71], v[104:107]
    v_mfma_f32_16x16x32_f16 v[100:103], v[36:39], v[64:67], v[100:103]
    v_mfma_f32_16x16x32_f16 v[124:127], v[40:43], v[84:87], v[124:127]
    v_mfma_f32_16x16x32_f16 v[120:123], v[40:43], v[80:83], v[120:123]
    v_mfma_f32_16x16x32_f16 v[116:119], v[40:43], v[76:79], v[116:119]
    v_mfma_f32_16x16x32_f16 v[112:115], v[40:43], v[72:75], v[112:115]
    v_mfma_f32_16x16x32_f16 v[108:111], v[40:43], v[68:71], v[108:111]
    v_mfma_f32_16x16x32_f16 v[104:107], v[40:43], v[64:67], v[104:107]
    v_mfma_f32_16x16x32_f16 v[124:127], v[44:47], v[80:83], v[124:127]
    v_mfma_f32_16x16x32_f16 v[120:123], v[44:47], v[76:79], v[120:123]
    v_mfma_f32_16x16x32_f16 v[116:119], v[44:47], v[72:75], v[116:119]
    v_mfma_f32_16x16x32_f16 v[112:115], v[44:47], v[68:71], v[112:115]
    v_mfma_f32_16x16x32_f16 v[108:111], v[44:47], v[64:67], v[108:111]
    v_mfma_f32_16x16x32_f16 v[124:127], v[48:51], v[76:79], v[124:127]
    v_mfma_f32_16x16x32_f16 v[120:123], v[48:51], v[72:75], v[120:123]
    v_mfma_f32_16x16x32_f16 v[116:119], v[48:51], v[68:71], v[116:119]
    v_mfma_f32_16x16x32_f16 v[112:115], v[48:51], v[64:67], v[112:115]
    v_mfma_f32_16x16x32_f16 v[124:127], v[52:55], v[72:75], v[124:127]
    v_mfma_f32_16x16x32_f16 v[120:123], v[52:55], v[68:71], v[120:123]
    v_mfma_f32_16x16x32_f16 v[116:119], v[52:55], v[64:67], v[116:119]
    s_waitcnt lgkmcnt(2)
    v_mfma_f32_16x16x32_f16 v[124:127], v[56:59], v[68:71], v[124:127]
    v_mfma_f32_16x16x32_f16 v[120:123], v[56:59], v[64:67], v[120:123]
    s_waitcnt lgkmcnt(0)
    v_mfma_f32_16x16x32_f16 v[124:127], v[60:63], v[64:67], v[124:127]
    v_add_u32 v26, s41, v25
    v_add_u32 v27, s39, v25
    ds_read_b64 v[32:33], v26 offset:512
    ds_read_b64 v[34:35], v26 offset:1024
    ds_read_b64 v[36:37], v26 offset:1536
    ds_read_b64 v[38:39], v26 offset:2048
    ds_read_b64 v[40:41], v26 offset:2560
    ds_read_b64 v[42:43], v26 offset:3072
    ds_read_b64 v[44:45], v26 offset:3584
    ds_read_b64 v[46:47], v26 offset:4096
    v_mov_b32 v28, 16256
    v_mov_b32 v29, 1065353216
    v_mov_b32 v11, v10
    s_waitcnt lgkmcnt(0)
    v_pk_mul_f32 v[96:97], v[96:97], v[10:11]
    v_pk_mul_f32 v[98:99], v[98:99], v[10:11]
    v_fma_mix_f32 v48, v32, s11, 0 op_sel:[0,0,0] op_sel_hi:[1,0,0]
    v_fma_mix_f32 v49, v32, s11, 0 op_sel:[1,0,0] op_sel_hi:[1,0,0]
    v_fma_mix_f32 v50, v33, s11, 0 op_sel:[0,0,0] op_sel_hi:[1,0,0]
    v_fma_mix_f32 v51, v33, s11, 0 op_sel:[1,0,0] op_sel_hi:[1,0,0]
    v_cvt_pk_bf16_f32 v96, v96, v97
    v_cvt_pk_bf16_f32 v97, v98, v99
    v_cvt_pk_bf16_f32 v52, v48, v49
    v_cvt_pk_bf16_f32 v53, v50, v51
    v_lshlrev_b32 v48, 16, v52
    v_and_b32 v49, 0xffff0000, v52
    v_lshlrev_b32 v50, 16, v53
    v_and_b32 v51, 0xffff0000, v53
    v_dot2_f32_bf16 v48, v96, v28, v48
    v_dot2_f32_bf16 v49, v96, v29, v49
    v_dot2_f32_bf16 v50, v97, v28, v50
    v_dot2_f32_bf16 v51, v97, v29, v51
    s_nop 0
    v_cvt_pk_bf16_f32 v98, v48, v49
    s_nop 0
    v_cvt_pk_bf16_f32 v99, v50, v51
    ds_write_b64 v27, v[98:99] offset:0
    v_pk_mul_f32 v[100:101], v[100:101], v[10:11]
    v_pk_mul_f32 v[102:103], v[102:103], v[10:11]
    v_fma_mix_f32 v56, v34, s11, 0 op_sel:[0,0,0] op_sel_hi:[1,0,0]
    v_fma_mix_f32 v57, v34, s11, 0 op_sel:[1,0,0] op_sel_hi:[1,0,0]
    v_fma_mix_f32 v58, v35, s11, 0 op_sel:[0,0,0] op_sel_hi:[1,0,0]
    v_fma_mix_f32 v59, v35, s11, 0 op_sel:[1,0,0] op_sel_hi:[1,0,0]
    v_cvt_pk_bf16_f32 v100, v100, v101
    v_cvt_pk_bf16_f32 v101, v102, v103
    v_cvt_pk_bf16_f32 v60, v56, v57
    v_cvt_pk_bf16_f32 v61, v58, v59
    v_lshlrev_b32 v56, 16, v60
    v_and_b32 v57, 0xffff0000, v60
    v_lshlrev_b32 v58, 16, v61
    v_and_b32 v59, 0xffff0000, v61
    v_dot2_f32_bf16 v56, v100, v28, v56
    v_dot2_f32_bf16 v57, v100, v29, v57
    v_dot2_f32_bf16 v58, v101, v28, v58
    v_dot2_f32_bf16 v59, v101, v29, v59
    s_nop 0
    v_cvt_pk_bf16_f32 v102, v56, v57
    s_nop 0
    v_cvt_pk_bf16_f32 v103, v58, v59
    ds_write_b64 v27, v[102:103] offset:512
    v_pk_mul_f32 v[104:105], v[104:105], v[10:11]
    v_pk_mul_f32 v[106:107], v[106:107], v[10:11]
    v_fma_mix_f32 v48, v36, s11, 0 op_sel:[0,0,0] op_sel_hi:[1,0,0]
    v_fma_mix_f32 v49, v36, s11, 0 op_sel:[1,0,0] op_sel_hi:[1,0,0]
    v_fma_mix_f32 v50, v37, s11, 0 op_sel:[0,0,0] op_sel_hi:[1,0,0]
    v_fma_mix_f32 v51, v37, s11, 0 op_sel:[1,0,0] op_sel_hi:[1,0,0]
    v_cvt_pk_bf16_f32 v104, v104, v105
    v_cvt_pk_bf16_f32 v105, v106, v107
    v_cvt_pk_bf16_f32 v52, v48, v49
    v_cvt_pk_bf16_f32 v53, v50, v51
    v_lshlrev_b32 v48, 16, v52
    v_and_b32 v49, 0xffff0000, v52
    v_lshlrev_b32 v50, 16, v53
    v_and_b32 v51, 0xffff0000, v53
    v_dot2_f32_bf16 v48, v104, v28, v48
    v_dot2_f32_bf16 v49, v104, v29, v49
    v_dot2_f32_bf16 v50, v105, v28, v50
    v_dot2_f32_bf16 v51, v105, v29, v51
    s_nop 0
    v_cvt_pk_bf16_f32 v106, v48, v49
    s_nop 0
    v_cvt_pk_bf16_f32 v107, v50, v51
    ds_write_b64 v27, v[106:107] offset:1024
    v_pk_mul_f32 v[108:109], v[108:109], v[10:11]
    v_pk_mul_f32 v[110:111], v[110:111], v[10:11]
    v_fma_mix_f32 v56, v38, s11, 0 op_sel:[0,0,0] op_sel_hi:[1,0,0]
    v_fma_mix_f32 v57, v38, s11, 0 op_sel:[1,0,0] op_sel_hi:[1,0,0]
    v_fma_mix_f32 v58, v39, s11, 0 op_sel:[0,0,0] op_sel_hi:[1,0,0]
    v_fma_mix_f32 v59, v39, s11, 0 op_sel:[1,0,0] op_sel_hi:[1,0,0]
    v_cvt_pk_bf16_f32 v108, v108, v109
    v_cvt_pk_bf16_f32 v109, v110, v111
    v_cvt_pk_bf16_f32 v60, v56, v57
    v_cvt_pk_bf16_f32 v61, v58, v59
    v_lshlrev_b32 v56, 16, v60
    v_and_b32 v57, 0xffff0000, v60
    v_lshlrev_b32 v58, 16, v61
    v_and_b32 v59, 0xffff0000, v61
    v_dot2_f32_bf16 v56, v108, v28, v56
    v_dot2_f32_bf16 v57, v108, v29, v57
    v_dot2_f32_bf16 v58, v109, v28, v58
    v_dot2_f32_bf16 v59, v109, v29, v59
    s_nop 0
    v_cvt_pk_bf16_f32 v110, v56, v57
    s_nop 0
    v_cvt_pk_bf16_f32 v111, v58, v59
    ds_write_b64 v27, v[110:111] offset:1536
    v_pk_mul_f32 v[112:113], v[112:113], v[10:11]
    v_pk_mul_f32 v[114:115], v[114:115], v[10:11]
    v_fma_mix_f32 v48, v40, s11, 0 op_sel:[0,0,0] op_sel_hi:[1,0,0]
    v_fma_mix_f32 v49, v40, s11, 0 op_sel:[1,0,0] op_sel_hi:[1,0,0]
    v_fma_mix_f32 v50, v41, s11, 0 op_sel:[0,0,0] op_sel_hi:[1,0,0]
    v_fma_mix_f32 v51, v41, s11, 0 op_sel:[1,0,0] op_sel_hi:[1,0,0]
    v_cvt_pk_bf16_f32 v112, v112, v113
    v_cvt_pk_bf16_f32 v113, v114, v115
    v_cvt_pk_bf16_f32 v52, v48, v49
    v_cvt_pk_bf16_f32 v53, v50, v51
    v_lshlrev_b32 v48, 16, v52
    v_and_b32 v49, 0xffff0000, v52
    v_lshlrev_b32 v50, 16, v53
    v_and_b32 v51, 0xffff0000, v53
    v_dot2_f32_bf16 v48, v112, v28, v48
    v_dot2_f32_bf16 v49, v112, v29, v49
    v_dot2_f32_bf16 v50, v113, v28, v50
    v_dot2_f32_bf16 v51, v113, v29, v51
    s_nop 0
    v_cvt_pk_bf16_f32 v114, v48, v49
    s_nop 0
    v_cvt_pk_bf16_f32 v115, v50, v51
    ds_write_b64 v27, v[114:115] offset:2048
    v_pk_mul_f32 v[116:117], v[116:117], v[10:11]
    v_pk_mul_f32 v[118:119], v[118:119], v[10:11]
    v_fma_mix_f32 v56, v42, s11, 0 op_sel:[0,0,0] op_sel_hi:[1,0,0]
    v_fma_mix_f32 v57, v42, s11, 0 op_sel:[1,0,0] op_sel_hi:[1,0,0]
    v_fma_mix_f32 v58, v43, s11, 0 op_sel:[0,0,0] op_sel_hi:[1,0,0]
    v_fma_mix_f32 v59, v43, s11, 0 op_sel:[1,0,0] op_sel_hi:[1,0,0]
    v_cvt_pk_bf16_f32 v116, v116, v117
    v_cvt_pk_bf16_f32 v117, v118, v119
    v_cvt_pk_bf16_f32 v60, v56, v57
    v_cvt_pk_bf16_f32 v61, v58, v59
    v_lshlrev_b32 v56, 16, v60
    v_and_b32 v57, 0xffff0000, v60
    v_lshlrev_b32 v58, 16, v61
    v_and_b32 v59, 0xffff0000, v61
    v_dot2_f32_bf16 v56, v116, v28, v56
    v_dot2_f32_bf16 v57, v116, v29, v57
    v_dot2_f32_bf16 v58, v117, v28, v58
    v_dot2_f32_bf16 v59, v117, v29, v59
    s_nop 0
    v_cvt_pk_bf16_f32 v118, v56, v57
    s_nop 0
    v_cvt_pk_bf16_f32 v119, v58, v59
    ds_write_b64 v27, v[118:119] offset:2560
    v_pk_mul_f32 v[120:121], v[120:121], v[10:11]
    v_pk_mul_f32 v[122:123], v[122:123], v[10:11]
    v_fma_mix_f32 v48, v44, s11, 0 op_sel:[0,0,0] op_sel_hi:[1,0,0]
    v_fma_mix_f32 v49, v44, s11, 0 op_sel:[1,0,0] op_sel_hi:[1,0,0]
    v_fma_mix_f32 v50, v45, s11, 0 op_sel:[0,0,0] op_sel_hi:[1,0,0]
    v_fma_mix_f32 v51, v45, s11, 0 op_sel:[1,0,0] op_sel_hi:[1,0,0]
    v_cvt_pk_bf16_f32 v120, v120, v121
    v_cvt_pk_bf16_f32 v121, v122, v123
    v_cvt_pk_bf16_f32 v52, v48, v49
    v_cvt_pk_bf16_f32 v53, v50, v51
    v_lshlrev_b32 v48, 16, v52
    v_and_b32 v49, 0xffff0000, v52
    v_lshlrev_b32 v50, 16, v53
    v_and_b32 v51, 0xffff0000, v53
    v_dot2_f32_bf16 v48, v120, v28, v48
    v_dot2_f32_bf16 v49, v120, v29, v49
    v_dot2_f32_bf16 v50, v121, v28, v50
    v_dot2_f32_bf16 v51, v121, v29, v51
    s_nop 0
    v_cvt_pk_bf16_f32 v122, v48, v49
    s_nop 0
    v_cvt_pk_bf16_f32 v123, v50, v51
    ds_write_b64 v27, v[122:123] offset:3072
    v_pk_mul_f32 v[124:125], v[124:125], v[10:11]
    v_pk_mul_f32 v[126:127], v[126:127], v[10:11]
    v_fma_mix_f32 v56, v46, s11, 0 op_sel:[0,0,0] op_sel_hi:[1,0,0]
    v_fma_mix_f32 v57, v46, s11, 0 op_sel:[1,0,0] op_sel_hi:[1,0,0]
    v_fma_mix_f32 v58, v47, s11, 0 op_sel:[0,0,0] op_sel_hi:[1,0,0]
    v_fma_mix_f32 v59, v47, s11, 0 op_sel:[1,0,0] op_sel_hi:[1,0,0]
    v_cvt_pk_bf16_f32 v124, v124, v125
    v_cvt_pk_bf16_f32 v125, v126, v127
    v_cvt_pk_bf16_f32 v60, v56, v57
    v_cvt_pk_bf16_f32 v61, v58, v59
    v_lshlrev_b32 v56, 16, v60
    v_and_b32 v57, 0xffff0000, v60
    v_lshlrev_b32 v58, 16, v61
    v_and_b32 v59, 0xffff0000, v61
    v_dot2_f32_bf16 v56, v124, v28, v56
    v_dot2_f32_bf16 v57, v124, v29, v57
    v_dot2_f32_bf16 v58, v125, v28, v58
    v_dot2_f32_bf16 v59, v125, v29, v59
    s_nop 0
    v_cvt_pk_bf16_f32 v126, v56, v57
    s_nop 0
    v_cvt_pk_bf16_f32 v127, v58, v59
    ds_write_b64 v27, v[126:127] offset:3584
    v_lshrrev_b32 v14, 2, v6
    v_mul_u32_u24 v14, 27712, v14
    v_and_b32 v15, 3, v2
    v_lshlrev_b32 v15, 3, v15
    v_add_u32 v14, v14, v15
    v_lshlrev_b32 v15, 5, v7
    v_add_u32 v14, v14, v15
    s_lshl_b32 s12, s3, 10
    v_add_u32 v14, s12, v14
    v_lshrrev_b32 v15, 3, v6
    v_lshlrev_b32 v16, 1, v7
    v_add_u32 v15, v15, v16
    v_mul_u32_u24 v15, 10240, v15
    v_and_b32 v16, 7, v6
    v_lshlrev_b32 v16, 3, v16
    v_add_u32 v15, v15, v16
    s_mul_i32 s12, s3, 655360
    s_lshl_b32 s13, s35, 6
    s_add_u32 s12, s12, s13
    s_add_u32 s12, s12, 4194304
    v_add_u32 v15, s12, v15
    s_waitcnt lgkmcnt(0)
    s_barrier
    ds_read_b64_tr_b16 v[40:41], v14 offset:0
    ds_read_b64_tr_b16 v[42:43], v14 offset:128
    ds_read_b64_tr_b16 v[44:45], v14 offset:256
    ds_read_b64_tr_b16 v[46:47], v14 offset:384
    ds_read_b64_tr_b16 v[48:49], v14 offset:512
    ds_read_b64_tr_b16 v[50:51], v14 offset:640
    ds_read_b64_tr_b16 v[52:53], v14 offset:768
    ds_read_b64_tr_b16 v[54:55], v14 offset:896
    s_waitcnt lgkmcnt(7)
    global_store_dwordx2 v15, v[40:41], s[32:33]
    v_add_u32 v15, 81920, v15
    s_waitcnt lgkmcnt(6)
    global_store_dwordx2 v15, v[42:43], s[32:33]
    v_add_u32 v15, 81920, v15
    s_waitcnt lgkmcnt(5)
    global_store_dwordx2 v15, v[44:45], s[32:33]
    v_add_u32 v15, 81920, v15
    s_waitcnt lgkmcnt(4)
    global_store_dwordx2 v15, v[46:47], s[32:33]
    v_add_u32 v15, 81920, v15
    s_waitcnt lgkmcnt(3)
    global_store_dwordx2 v15, v[48:49], s[32:33]
    v_add_u32 v15, 81920, v15
    s_waitcnt lgkmcnt(2)
    global_store_dwordx2 v15, v[50:51], s[32:33]
    v_add_u32 v15, 81920, v15
    s_waitcnt lgkmcnt(1)
    global_store_dwordx2 v15, v[52:53], s[32:33]
    v_add_u32 v15, 81920, v15
    s_waitcnt lgkmcnt(0)
    global_store_dwordx2 v15, v[54:55], s[32:33]
    s_endpgm
KA_LN1:
    s_setprio 3
    v_mov_b32 v20, v0
    s_mul_i32 s5, s2, 10240
    v_min_u32 v21, 159, v20
    v_lshlrev_b32 v3, 3, v21
    v_add_u32 v3, s5, v3
    v_add_u32 v4, 5120, v3
    v_lshrrev_b32 v5, 4, v20
    v_mul_u32_u24 v6, 1280, v5
    v_and_b32 v7, 15, v20
    v_lshlrev_b32 v7, 4, v7
    v_add_u32 v6, v6, v7
    v_add_u32 v6, s5, v6
    s_cmp_eq_u32 s3, 2
    s_cbranch_scc1 KA_LNB
    global_load_dwordx4 v[24:27], v6, s[16:17] offset:0
    global_load_dwordx4 v[28:31], v6, s[16:17] offset:256
    global_load_dwordx4 v[32:35], v6, s[16:17] offset:512
    global_load_dwordx4 v[36:39], v6, s[16:17] offset:768
    global_load_dwordx4 v[40:43], v6, s[16:17] offset:1024
KA_LNB:
    global_load_dwordx2 v[48:49], v3, s[16:17] offset:0
    global_load_dwordx2 v[50:51], v3, s[16:17] offset:1280
    global_load_dwordx2 v[52:53], v3, s[16:17] offset:2560
    global_load_dwordx2 v[54:55], v3, s[16:17] offset:3840
    global_load_dwordx2 v[56:57], v4, s[16:17] offset:0
    global_load_dwordx2 v[58:59], v4, s[16:17] offset:1280
    global_load_dwordx2 v[60:61], v4, s[16:17] offset:2560
    global_load_dwordx2 v[62:63], v4, s[16:17] offset:3840
    v_mov_b32 v14, 16256
    v_mov_b32 v15, 1065353216
    s_cmp_eq_u32 s3, 2
    s_cbranch_scc1 KA_P1
    v_mov_b32 v8, 0
    v_mov_b32 v9, 0
    v_mov_b32 v10, 0
    v_mov_b32 v11, 0
    v_mov_b32 v12, 0x3f803f80
    s_waitcnt vmcnt(8)
    v_dot2c_f32_bf16 v8, v24, v12
    v_dot2c_f32_bf16 v9, v24, v24
    v_dot2c_f32_bf16 v10, v25, v12
    v_dot2c_f32_bf16 v11, v25, v25
    v_dot2c_f32_bf16 v8, v26, v12
    v_dot2c_f32_bf16 v9, v26, v26
    v_dot2c_f32_bf16 v10, v27, v12
    v_dot2c_f32_bf16 v11, v27, v27
    v_dot2c_f32_bf16 v8, v28, v12
    v_dot2c_f32_bf16 v9, v28, v28
    v_dot2c_f32_bf16 v10, v29, v12
    v_dot2c_f32_bf16 v11, v29, v29
    v_dot2c_f32_bf16 v8, v30, v12
    v_dot2c_f32_bf16 v9, v30, v30
    v_dot2c_f32_bf16 v10, v31, v12
    v_dot2c_f32_bf16 v11, v31, v31
    v_dot2c_f32_bf16 v8, v32, v12
    v_dot2c_f32_bf16 v9, v32, v32
    v_dot2c_f32_bf16 v10, v33, v12
    v_dot2c_f32_bf16 v11, v33, v33
    v_dot2c_f32_bf16 v8, v34, v12
    v_dot2c_f32_bf16 v9, v34, v34
    v_dot2c_f32_bf16 v10, v35, v12
    v_dot2c_f32_bf16 v11, v35, v35
    v_dot2c_f32_bf16 v8, v36, v12
    v_dot2c_f32_bf16 v9, v36, v36
    v_dot2c_f32_bf16 v10, v37, v12
    v_dot2c_f32_bf16 v11, v37, v37
    v_dot2c_f32_bf16 v8, v38, v12
    v_dot2c_f32_bf16 v9, v38, v38
    v_dot2c_f32_bf16 v10, v39, v12
    v_dot2c_f32_bf16 v11, v39, v39
    v_dot2c_f32_bf16 v8, v40, v12
    v_dot2c_f32_bf16 v9, v40, v40
    v_dot2c_f32_bf16 v10, v41, v12
    v_dot2c_f32_bf16 v11, v41, v41
    v_dot2c_f32_bf16 v8, v42, v12
    v_dot2c_f32_bf16 v9, v42, v42
    v_dot2c_f32_bf16 v10, v43, v12
    v_dot2c_f32_bf16 v11, v43, v43
    s_nop 2
    v_add_f32 v8, v8, v10
    v_add_f32 v9, v9, v11
    s_nop 0
    v_add_f32_dpp v8, v8, v8 row_ror:8 row_mask:0xf bank_mask:0xf
    v_add_f32_dpp v9, v9, v9 row_ror:8 row_mask:0xf bank_mask:0xf
    s_nop 0
    v_add_f32_dpp v8, v8, v8 row_ror:4 row_mask:0xf bank_mask:0xf
    v_add_f32_dpp v9, v9, v9 row_ror:4 row_mask:0xf bank_mask:0xf
    s_nop 0
    v_add_f32_dpp v8, v8, v8 row_ror:2 row_mask:0xf bank_mask:0xf
    v_add_f32_dpp v9, v9, v9 row_ror:2 row_mask:0xf bank_mask:0xf
    s_nop 0
    v_add_f32_dpp v8, v8, v8 row_ror:1 row_mask:0xf bank_mask:0xf
    v_add_f32_dpp v9, v9, v9 row_ror:1 row_mask:0xf bank_mask:0xf
    v_mul_f32 v8, 986500301, v8
    v_mul_f32 v9, 986500301, v9
    v_fma_f32 v9, -v8, v8, v9
    v_max_f32 v9, 0, v9
    v_cvt_pk_bf16_f32 v10, v8, v9
    v_lshlrev_b32 v8, 16, v10
    v_and_b32 v9, 0xffff0000, v10
    v_add_f32 v9, 925353388, v9
    v_cvt_pk_bf16_f32 v9, v9, v9
    v_and_b32 v9, 0xffff0000, v9
    v_sqrt_f32 v9, v9
    s_nop 0
    v_cvt_pk_bf16_f32 v9, v9, v9
    v_and_b32 v9, 0xffff0000, v9
    v_rcp_f32 v9, v9
    v_sub_f32 v8, 0, v8
    v_lshlrev_b32 v5, 3, v5
    v_add_u32 v5, 135616, v5
    ds_write_b64 v5, v[8:9]
KA_P1:
    s_waitcnt lgkmcnt(0)
    v_mov_b32 v18, 135488
    v_mov_b32 v19, 1
    s_mov_b64 exec, 1
    ds_add_u32 v18, v19
    s_mov_b64 exec, -1
    s_mov_b32 s12, 0
KA_GS0:
    ds_read_b32 v19, v18
    s_waitcnt lgkmcnt(0)
    v_readfirstlane_b32 s13, v19
    s_nop 0
    s_cmp_ge_u32 s13, 3
    s_cbranch_scc1 KA_GS0_OK
    s_add_u32 s12, s12, 1
    s_cmp_lt_u32 s12, 4194304
    s_cbranch_scc1 KA_GS0
KA_GS0_OK:
    v_mov_b32 v5, 135616
    ds_read_b128 v[24:27], v5 offset:0
    ds_read_b128 v[28:31], v5 offset:16
    ds_read_b128 v[32:35], v5 offset:32
    ds_read_b128 v[36:39], v5 offset:48
    v_lshlrev_b32 v3, 6, v21
    v_add_u32 v3, 135680, v3
    s_waitcnt vmcnt(0) lgkmcnt(0)
    v_dot2_f32_bf16 v84, v48, v14, v24
    v_dot2_f32_bf16 v85, v50, v14, v26
    v_dot2_f32_bf16 v87, v48, v15, v24
    v_dot2_f32_bf16 v88, v50, v15, v26
    v_dot2_f32_bf16 v90, v49, v14, v24
    v_dot2_f32_bf16 v91, v51, v14, v26
    v_dot2_f32_bf16 v93, v49, v15, v24
    v_dot2_f32_bf16 v94, v51, v15, v26
    v_cvt_pk_bf16_f32 v86, v84, v85
    v_cvt_pk_bf16_f32 v89, v87, v88
    v_cvt_pk_bf16_f32 v92, v90, v91
    v_cvt_pk_bf16_f32 v95, v93, v94
    v_lshlrev_b32 v84, 16, v86
    v_and_b32 v85, 0xffff0000, v86
    v_lshlrev_b32 v87, 16, v89
    v_and_b32 v88, 0xffff0000, v89
    v_lshlrev_b32 v90, 16, v92
    v_and_b32 v91, 0xffff0000, v92
    v_lshlrev_b32 v93, 16, v95
    v_and_b32 v94, 0xffff0000, v95
    v_mul_f32 v84, v84, v25
    v_mul_f32 v85, v85, v27
    v_mul_f32 v87, v87, v25
    v_mul_f32 v88, v88, v27
    v_mul_f32 v90, v90, v25
    v_mul_f32 v91, v91, v27
    v_mul_f32 v93, v93, v25
    v_mul_f32 v94, v94, v27
    v_cvt_pk_bf16_f32 v86, v84, v85
    v_cvt_pk_bf16_f32 v89, v87, v88
    v_cvt_pk_bf16_f32 v92, v90, v91
    v_cvt_pk_bf16_f32 v95, v93, v94
    v_lshlrev_b32 v84, 16, v86
    v_and_b32 v85, 0xffff0000, v86
    v_lshlrev_b32 v87, 16, v89
    v_and_b32 v88, 0xffff0000, v89
    v_lshlrev_b32 v90, 16, v92
    v_and_b32 v91, 0xffff0000, v92
    v_lshlrev_b32 v93, 16, v95
    v_and_b32 v94, 0xffff0000, v95
    v_cvt_pk_f16_f32 v68, v84, v85
    v_cvt_pk_f16_f32 v72, v87, v88
    v_cvt_pk_f16_f32 v76, v90, v91
    v_cvt_pk_f16_f32 v80, v93, v94
    v_dot2_f32_bf16 v84, v52, v14, v28
    v_dot2_f32_bf16 v85, v54, v14, v30
    v_dot2_f32_bf16 v87, v52, v15, v28
    v_dot2_f32_bf16 v88, v54, v15, v30
    v_dot2_f32_bf16 v90, v53, v14, v28
    v_dot2_f32_bf16 v91, v55, v14, v30
    v_dot2_f32_bf16 v93, v53, v15, v28
    v_dot2_f32_bf16 v94, v55, v15, v30
    v_cvt_pk_bf16_f32 v86, v84, v85
    v_cvt_pk_bf16_f32 v89, v87, v88
    v_cvt_pk_bf16_f32 v92, v90, v91
    v_cvt_pk_bf16_f32 v95, v93, v94
    v_lshlrev_b32 v84, 16, v86
    v_and_b32 v85, 0xffff0000, v86
    v_lshlrev_b32 v87, 16, v89
    v_and_b32 v88, 0xffff0000, v89
    v_lshlrev_b32 v90, 16, v92
    v_and_b32 v91, 0xffff0000, v92
    v_lshlrev_b32 v93, 16, v95
    v_and_b32 v94, 0xffff0000, v95
    v_mul_f32 v84, v84, v29
    v_mul_f32 v85, v85, v31
    v_mul_f32 v87, v87, v29
    v_mul_f32 v88, v88, v31
    v_mul_f32 v90, v90, v29
    v_mul_f32 v91, v91, v31
    v_mul_f32 v93, v93, v29
    v_mul_f32 v94, v94, v31
    v_cvt_pk_bf16_f32 v86, v84, v85
    v_cvt_pk_bf16_f32 v89, v87, v88
    v_cvt_pk_bf16_f32 v92, v90, v91
    v_cvt_pk_bf16_f32 v95, v93, v94
    v_lshlrev_b32 v84, 16, v86
    v_and_b32 v85, 0xffff0000, v86
    v_lshlrev_b32 v87, 16, v89
    v_and_b32 v88, 0xffff0000, v89
    v_lshlrev_b32 v90, 16, v92
    v_and_b32 v91, 0xffff0000, v92
    v_lshlrev_b32 v93, 16, v95
    v_and_b32 v94, 0xffff0000, v95
    v_cvt_pk_f16_f32 v69, v84, v85
    v_cvt_pk_f16_f32 v73, v87, v88
    v_cvt_pk_f16_f32 v77, v90, v91
    v_cvt_pk_f16_f32 v81, v93, v94
    v_dot2_f32_bf16 v84, v56, v14, v32
    v_dot2_f32_bf16 v85, v58, v14, v34
    v_dot2_f32_bf16 v87, v56, v15, v32
    v_dot2_f32_bf16 v88, v58, v15, v34
    v_dot2_f32_bf16 v90, v57, v14, v32
    v_dot2_f32_bf16 v91, v59, v14, v34
    v_dot2_f32_bf16 v93, v57, v15, v32
    v_dot2_f32_bf16 v94, v59, v15, v34
    v_cvt_pk_bf16_f32 v86, v84, v85
    v_cvt_pk_bf16_f32 v89, v87, v88
    v_cvt_pk_bf16_f32 v92, v90, v91
    v_cvt_pk_bf16_f32 v95, v93, v94
    v_lshlrev_b32 v84, 16, v86
    v_and_b32 v85, 0xffff0000, v86
    v_lshlrev_b32 v87, 16, v89
    v_and_b32 v88, 0xffff0000, v89
    v_lshlrev_b32 v90, 16, v92
    v_and_b32 v91, 0xffff0000, v92
    v_lshlrev_b32 v93, 16, v95
    v_and_b32 v94, 0xffff0000, v95
    v_mul_f32 v84, v84, v33
    v_mul_f32 v85, v85, v35
    v_mul_f32 v87, v87, v33
    v_mul_f32 v88, v88, v35
    v_mul_f32 v90, v90, v33
    v_mul_f32 v91, v91, v35
    v_mul_f32 v93, v93, v33
    v_mul_f32 v94, v94, v35
    v_cvt_pk_bf16_f32 v86, v84, v85
    v_cvt_pk_bf16_f32 v89, v87, v88
    v_cvt_pk_bf16_f32 v92, v90, v91
    v_cvt_pk_bf16_f32 v95, v93, v94
    v_lshlrev_b32 v84, 16, v86
    v_and_b32 v85, 0xffff0000, v86
    v_lshlrev_b32 v87, 16, v89
    v_and_b32 v88, 0xffff0000, v89
    v_lshlrev_b32 v90, 16, v92
    v_and_b32 v91, 0xffff0000, v92
    v_lshlrev_b32 v93, 16, v95
    v_and_b32 v94, 0xffff0000, v95
    v_cvt_pk_f16_f32 v70, v84, v85
    v_cvt_pk_f16_f32 v74, v87, v88
    v_cvt_pk_f16_f32 v78, v90, v91
    v_cvt_pk_f16_f32 v82, v93, v94
    v_dot2_f32_bf16 v84, v60, v14, v36
    v_dot2_f32_bf16 v85, v62, v14, v38
    v_dot2_f32_bf16 v87, v60, v15, v36
    v_dot2_f32_bf16 v88, v62, v15, v38
    v_dot2_f32_bf16 v90, v61, v14, v36
    v_dot2_f32_bf16 v91, v63, v14, v38
    v_dot2_f32_bf16 v93, v61, v15, v36
    v_dot2_f32_bf16 v94, v63, v15, v38
    v_cvt_pk_bf16_f32 v86, v84, v85
    v_cvt_pk_bf16_f32 v89, v87, v88
    v_cvt_pk_bf16_f32 v92, v90, v91
    v_cvt_pk_bf16_f32 v95, v93, v94
    v_lshlrev_b32 v84, 16, v86
    v_and_b32 v85, 0xffff0000, v86
    v_lshlrev_b32 v87, 16, v89
    v_and_b32 v88, 0xffff0000, v89
    v_lshlrev_b32 v90, 16, v92
    v_and_b32 v91, 0xffff0000, v92
    v_lshlrev_b32 v93, 16, v95
    v_and_b32 v94, 0xffff0000, v95
    v_mul_f32 v84, v84, v37
    v_mul_f32 v85, v85, v39
    v_mul_f32 v87, v87, v37
    v_mul_f32 v88, v88, v39
    v_mul_f32 v90, v90, v37
    v_mul_f32 v91, v91, v39
    v_mul_f32 v93, v93, v37
    v_mul_f32 v94, v94, v39
    v_cvt_pk_bf16_f32 v86, v84, v85
    v_cvt_pk_bf16_f32 v89, v87, v88
    v_cvt_pk_bf16_f32 v92, v90, v91
    v_cvt_pk_bf16_f32 v95, v93, v94
    v_lshlrev_b32 v84, 16, v86
    v_and_b32 v85, 0xffff0000, v86
    v_lshlrev_b32 v87, 16, v89
    v_and_b32 v88, 0xffff0000, v89
    v_lshlrev_b32 v90, 16, v92
    v_and_b32 v91, 0xffff0000, v92
    v_lshlrev_b32 v93, 16, v95
    v_and_b32 v94, 0xffff0000, v95
    v_cvt_pk_f16_f32 v71, v84, v85
    v_cvt_pk_f16_f32 v75, v87, v88
    v_cvt_pk_f16_f32 v79, v90, v91
    v_cvt_pk_f16_f32 v83, v93, v94
    ds_write_b128 v3, v[68:71] offset:0
    ds_write_b128 v3, v[72:75] offset:16
    ds_write_b128 v3, v[76:79] offset:32
    ds_write_b128 v3, v[80:83] offset:48
    s_waitcnt lgkmcnt(0)
    v_mov_b32 v18, 135492
    v_mov_b32 v19, 1
    s_mov_b64 exec, 1
    ds_add_u32 v18, v19
    s_mov_b64 exec, -1
    s_mov_b32 s12, 0
KA_GS1:
    ds_read_b32 v19, v18
    s_waitcnt lgkmcnt(0)
    v_readfirstlane_b32 s13, v19
    s_nop 0
    s_cmp_ge_u32 s13, 3
    s_cbranch_scc1 KA_GS1_OK
    s_add_u32 s12, s12, 1
    s_cmp_lt_u32 s12, 4194304
    s_cbranch_scc1 KA_GS1
KA_GS1_OK:
    v_lshlrev_b32 v3, 4, v20
    v_add_u32 v4, 135680, v3
    ds_read_b128 v[24:27], v4 offset:0
    ds_read_b128 v[28:31], v4 offset:3072
    ds_read_b128 v[32:35], v4 offset:6144
    ds_read_b128 v[36:39], v4 offset:9216
    s_add_u32 s5, s5, 0
    v_add_u32 v3, s5, v3
    s_waitcnt lgkmcnt(0)
    global_store_dwordx4 v3, v[24:27], s[32:33] sc1
    v_add_u32 v3, 3072, v3
    global_store_dwordx4 v3, v[28:31], s[32:33] sc1
    v_add_u32 v3, 3072, v3
    global_store_dwordx4 v3, v[32:35], s[32:33] sc1
    v_add_u32 v3, 3072, v3
    s_cmp_lg_u32 s3, 0
    s_cbranch_scc1 KA_P3
    global_store_dwordx4 v3, v[36:39], s[32:33] sc1
KA_P3:
    s_waitcnt vmcnt(0)
    s_waitcnt lgkmcnt(0)
    v_mov_b32 v18, 135500
    v_mov_b32 v19, 1
    s_mov_b64 exec, 1
    ds_add_u32 v18, v19
    s_mov_b64 exec, -1
    s_mov_b32 s12, 0
KA_GS3:
    ds_read_b32 v19, v18
    s_waitcnt lgkmcnt(0)
    v_readfirstlane_b32 s13, v19
    s_nop 0
    s_cmp_ge_u32 s13, 4
    s_cbranch_scc1 KA_GS3_OK
    s_add_u32 s12, s12, 1
    s_cmp_lt_u32 s12, 4194304
    s_cbranch_scc1 KA_GS3
KA_GS3_OK:
    s_cmp_lg_u32 s3, 0
    s_cbranch_scc1 KA_LNX
    v_mov_b32 v3, 135584
    ds_read_b32 v4, v3
    s_lshr_b32 s5, s2, 2
    s_lshl_b32 s5, s5, 7
    s_and_b32 s6, s2, 3
    s_lshl_b32 s6, s6, 2
    s_add_u32 s5, s5, s6
    s_add_u32 s5, s5, 9633792
    v_mov_b32 v3, s5
    s_waitcnt lgkmcnt(0)
    s_mov_b64 exec, 1
    global_store_dword v3, v4, s[32:33] sc1
    s_mov_b64 exec, -1
KA_LNX:
    s_setprio 0
    s_cmp_ge_u32 s2, 96
    s_cbranch_scc1 KA_CONV
    s_endpgm
KA_WTPOLL:
    v_mov_b32 v18, 135500
    s_mov_b32 s12, 0
KA_OWN2:
    ds_read_b32 v19, v18
    s_waitcnt lgkmcnt(0)
    v_readfirstlane_b32 s13, v19
    s_nop 0
    s_cmp_ge_u32 s13, 4
    s_cbranch_scc1 KA_OWN2_OK
    s_add_u32 s12, s12, 1
    s_sleep 4
    s_cmp_lt_u32 s12, 4194304
    s_cbranch_scc1 KA_OWN2
KA_OWN2_OK:
    s_waitcnt lgkmcnt(0)
    v_mov_b32 v18, 135552
    v_mov_b32 v19, 1
    s_mov_b64 exec, 1
    ds_add_u32 v18, v19
    s_mov_b64 exec, -1
    s_endpgm
KA_WT0:
    s_cmp_ge_u32 s3, 8
    s_cbranch_scc1 KA_PRE
    v_mov_b32 v18, 135552
    s_mov_b32 s12, 0
KA_WTW:
    ds_read_b32 v19, v18
    s_waitcnt lgkmcnt(0)
    v_readfirstlane_b32 s13, v19
    s_nop 0
    s_cmp_ge_u32 s13, 1
    s_cbranch_scc1 KA_WTW_OK
    s_add_u32 s12, s12, 1
    s_sleep 8
    s_cmp_lt_u32 s12, 4194304
    s_cbranch_scc1 KA_WTW
KA_WTW_OK:
KA_WTR:
    s_load_dwordx4 s[16:19], s[0:1], 72
    s_load_dwordx2 s[20:21], s[0:1], 88
    v_lshrrev_b32 v1, 6, v0
    s_nop 0
    v_readfirstlane_b32 s3, v1
    v_and_b32 v2, 63, v0
    s_sub_u32 s4, s3, 4
    s_mul_i32 s4, s4, 96
    s_add_u32 s4, s4, s2
    s_mul_i32 s5, s3, 8192
    v_lshrrev_b32 v3, 3, v2
    v_and_b32 v4, 7, v2
    v_lshlrev_b32 v4, 4, v4
    v_lshrrev_b32 v5, 4, v2
    v_lshlrev_b32 v5, 3, v5
    v_and_b32 v6, 15, v2
    v_lshrrev_b32 v6, 2, v6
    v_add_u32 v5, v5, v6
    v_lshlrev_b32 v5, 7, v5
    v_and_b32 v6, 3, v2
    v_lshlrev_b32 v7, 3, v6
    v_add_u32 v8, v5, v7
    v_add_u32 v8, s5, v8
    v_add_u32 v9, 4080, v8
    v_cmp_gt_u32 vcc, 2, v6
    s_nop 1
    v_cndmask_b32 v9, v9, v8, vcc
    v_lshlrev_b32 v10, 4, v2
    v_and_b32 v13, 15, v2
    v_lshrrev_b32 v14, 3, v13
    v_mul_u32_u24 v14, 24576, v14
    v_and_b32 v13, 7, v13
    v_lshlrev_b32 v13, 4, v13
    v_add_u32 v14, v14, v13
    v_lshrrev_b32 v13, 4, v2
    v_lshlrev_b32 v13, 7, v13
    v_add_u32 v14, v14, v13
    v_mul_u32_u24 v50, 3072, v3
    v_add_u32 v50, v50, v4
    v_mul_u32_u24 v51, 1280, v3
    v_add_u32 v51, v51, v4
    s_waitcnt lgkmcnt(0)
    s_mov_b32 s6, s4
    s_cmp_ge_u32 s6, 960
    s_cbranch_scc1 KA_WT_FIN
KA_WT_LOOP:
    s_cmp_ge_u32 s6, 480
    s_cbranch_scc1 KA_WT_DOWN
    s_mul_hi_u32 s7, s6, 0xccccccd
    s_mul_i32 s8, s7, 20
    s_sub_u32 s8, s6, s8
    s_mul_i32 s9, s8, 98304
    s_lshl_b32 s10, s7, 7
    s_add_u32 s9, s9, s10
    v_add_u32 v11, s9, v50
    s_add_u32 s10, s5, 0
    s_mov_b32 m0, s10
    s_nop 0
    global_load_lds_dwordx4 v11, s[16:17]
    s_add_u32 s10, s5, 4096
    s_mov_b32 m0, s10
    s_nop 0
    global_load_lds_dwordx4 v11, s[18:19]
    v_add_u32 v11, 24576, v11
    s_add_u32 s10, s5, 1024
    s_mov_b32 m0, s10
    s_nop 0
    global_load_lds_dwordx4 v11, s[16:17]
    s_add_u32 s10, s5, 5120
    s_mov_b32 m0, s10
    s_nop 0
    global_load_lds_dwordx4 v11, s[18:19]
    v_add_u32 v11, 24576, v11
    s_add_u32 s10, s5, 2048
    s_mov_b32 m0, s10
    s_nop 0
    global_load_lds_dwordx4 v11, s[16:17]
    s_add_u32 s10, s5, 6144
    s_mov_b32 m0, s10
    s_nop 0
    global_load_lds_dwordx4 v11, s[18:19]
    v_add_u32 v11, 24576, v11
    s_add_u32 s10, s5, 3072
    s_mov_b32 m0, s10
    s_nop 0
    global_load_lds_dwordx4 v11, s[16:17]
    s_add_u32 s10, s5, 7168
    s_mov_b32 m0, s10
    s_nop 0
    global_load_lds_dwordx4 v11, s[18:19]
    s_mul_i32 s9, s7, 163840
    s_lshl_b32 s10, s8, 10
    s_add_u32 s9, s9, s10
    s_add_u32 s9, s9, 10485760
    v_add_u32 v12, s9, v10
    s_waitcnt vmcnt(0)
    ds_read_b64_tr_b16 v[16:17], v9 offset:0
    ds_read_b64_tr_b16 v[18:19], v9 offset:512
    ds_read_b64_tr_b16 v[20:21], v9 offset:16
    ds_read_b64_tr_b16 v[22:23], v9 offset:528
    ds_read_b64_tr_b16 v[24:25], v9 offset:32
    ds_read_b64_tr_b16 v[26:27], v9 offset:544
    ds_read_b64_tr_b16 v[28:29], v9 offset:48
    ds_read_b64_tr_b16 v[30:31], v9 offset:560
    ds_read_b64_tr_b16 v[32:33], v9 offset:64
    ds_read_b64_tr_b16 v[34:35], v9 offset:576
    ds_read_b64_tr_b16 v[36:37], v9 offset:80
    ds_read_b64_tr_b16 v[38:39], v9 offset:592
    ds_read_b64_tr_b16 v[40:41], v9 offset:96
    ds_read_b64_tr_b16 v[42:43], v9 offset:608
    ds_read_b64_tr_b16 v[44:45], v9 offset:112
    ds_read_b64_tr_b16 v[46:47], v9 offset:624
    s_waitcnt lgkmcnt(0)
    global_store_dwordx4 v12, v[16:19], s[32:33] sc1
    v_add_u32 v12, 20480, v12
    global_store_dwordx4 v12, v[20:23], s[32:33] sc1
    v_add_u32 v12, 20480, v12
    global_store_dwordx4 v12, v[24:27], s[32:33] sc1
    v_add_u32 v12, 20480, v12
    global_store_dwordx4 v12, v[28:31], s[32:33] sc1
    v_add_u32 v12, 20480, v12
    global_store_dwordx4 v12, v[32:35], s[32:33] sc1
    v_add_u32 v12, 20480, v12
    global_store_dwordx4 v12, v[36:39], s[32:33] sc1
    v_add_u32 v12, 20480, v12
    global_store_dwordx4 v12, v[40:43], s[32:33] sc1
    v_add_u32 v12, 20480, v12
    global_store_dwordx4 v12, v[44:47], s[32:33] sc1
    s_branch KA_WT_NEXT
KA_WT_DOWN:
    s_sub_u32 s11, s6, 480
    s_mul_hi_u32 s7, s11, 0x5555556
    s_mul_i32 s8, s7, 48
    s_sub_u32 s8, s11, s8
    s_mul_i32 s9, s8, 40960
    s_lshl_b32 s10, s7, 7
    s_add_u32 s9, s9, s10
    v_add_u32 v11, s9, v51
    s_add_u32 s10, s5, 0
    s_mov_b32 m0, s10
    s_nop 0
    global_load_lds_dwordx4 v11, s[20:21]
    v_add_u32 v11, 10240, v11
    s_add_u32 s10, s5, 1024
    s_mov_b32 m0, s10
    s_nop 0
    global_load_lds_dwordx4 v11, s[20:21]
    v_add_u32 v11, 10240, v11
    s_add_u32 s10, s5, 2048
    s_mov_b32 m0, s10
    s_nop 0
    global_load_lds_dwordx4 v11, s[20:21]
    v_add_u32 v11, 10240, v11
    s_add_u32 s10, s5, 3072
    s_mov_b32 m0, s10
    s_nop 0
    global_load_lds_dwordx4 v11, s[20:21]
    s_mul_i32 s9, s7, 196608
    s_lshl_b32 s10, s8, 9
    s_add_u32 s9, s9, s10
    s_add_u32 s9, s9, 14680064
    v_add_u32 v12, s9, v14
    s_waitcnt vmcnt(0)
    ds_read_b64_tr_b16 v[16:17], v8 offset:0
    ds_read_b64_tr_b16 v[18:19], v8 offset:512
    ds_read_b64_tr_b16 v[20:21], v8 offset:32
    ds_read_b64_tr_b16 v[22:23], v8 offset:544
    ds_read_b64_tr_b16 v[24:25], v8 offset:64
    ds_read_b64_tr_b16 v[26:27], v8 offset:576
    ds_read_b64_tr_b16 v[28:29], v8 offset:96
    ds_read_b64_tr_b16 v[30:31], v8 offset:608
    s_waitcnt lgkmcnt(0)
    global_store_dwordx4 v12, v[16:19], s[32:33] sc1
    v_add_u32 v12, 49152, v12
    global_store_dwordx4 v12, v[20:23], s[32:33] sc1
    v_add_u32 v12, 49152, v12
    global_store_dwordx4 v12, v[24:27], s[32:33] sc1
    v_add_u32 v12, 49152, v12
    global_store_dwordx4 v12, v[28:31], s[32:33] sc1
KA_WT_NEXT:
    s_add_u32 s6, s6, 384
    s_cmp_lt_u32 s6, 960
    s_cbranch_scc1 KA_WT_LOOP
KA_WT_FIN:
    s_endpgm
KA_PRE:
    s_cmp_lg_u32 s3, 8
    s_cbranch_scc1 KA_WTX
    s_cmp_ge_u32 s2, 32
    s_cbranch_scc1 KA_WTX
    s_lshl_b32 s4, s2, 10
    s_add_u32 s5, s4, 9437184
    s_add_u32 s6, s4, 9494528
    s_cmp_lt_u32 s2, 8
    s_cselect_b32 s5, s5, s6
    v_lshlrev_b32 v3, 4, v2
    v_add_u32 v3, s5, v3
    v_mov_b32 v4, -1
    v_mov_b32 v5, -1
    v_mov_b32 v6, -1
    v_mov_b32 v7, -1
    global_store_dwordx4 v3, v[4:7], s[32:33]
KA_WTX:
    s_endpgm
KA_END:
    s_endpgm
.globl kd_kernel
.p2align 8
.type kd_kernel,@function
kd_kernel:
    s_cmp_ge_u32 s2, 256
    s_cbranch_scc1 KD_END
    s_load_dwordx2 s[32:33], s[0:1], 112
    s_load_dwordx2 s[26:27], s[0:1], 0
    s_load_dwordx2 s[28:29], s[0:1], 64
    s_load_dwordx2 s[30:31], s[0:1], 96
    v_lshrrev_b32 v1, 6, v0
    s_nop 0
    v_readfirstlane_b32 s3, v1
    v_and_b32 v2, 63, v0
    s_and_b32 s35, s3, 3
    s_cmp_ge_u32 s2, 192
    s_cselect_b32 s36, 1, 0
    s_sub_u32 s34, s2, 192
    s_cmp_lt_u32 s34, 16
    s_cselect_b32 s38, s36, 0
    s_mov_b32 s37, s2
    s_mul_i32 s7, s37, 20480
    s_mul_i32 s8, s35, 5120
    s_add_u32 s7, s7, s8
    s_add_u32 s7, s7, 10485760
    v_lshlrev_b32 v96, 4, v2
    v_add_u32 v96, s7, v96
    v_add_u32 v97, 4096, v96
    v_lshrrev_b32 v5, 4, v2
    v_and_b32 v4, 7, v2
    v_bfe_u32 v6, v2, 3, 1
    v_lshlrev_b32 v98, 7, v5
    v_lshl_add_u32 v98, v4, 4, v98
    v_lshl_add_u32 v98, v6, 9, v98
    s_mul_i32 s5, s3, 3072
    v_add_u32 v98, s5, v98
    v_add_u32 v99, 9502720, v98
    s_mul_i32 s4, s34, 24576
    s_add_u32 s4, s4, 14680064
    v_add_u32 v98, s4, v98
    v_add_u32 v95, 1572864, v98
    s_cmp_lt_u32 s3, 4
    s_cbranch_scc1 KD_ROW
    s_cmp_eq_u32 s36, 0
    s_cbranch_scc1 KD_END
    s_waitcnt lgkmcnt(0)
    s_sleep 32
    s_cmp_eq_u32 s36, 1
    s_cbranch_scc1 KD_L2_hi
    global_load_dwordx4 v[100:103], v96, s[32:33] offset:0
    global_load_dwordx4 v[104:107], v96, s[32:33] offset:1024
    global_load_dwordx4 v[108:111], v96, s[32:33] offset:2048
    global_load_dwordx4 v[112:115], v96, s[32:33] offset:3072
    global_load_dwordx4 v[116:119], v97, s[32:33]
    s_branch KD_LX_hi
KD_L2_hi:
    global_load_dwordx4 v[100:103], v98, s[32:33] offset:0
    global_load_dwordx4 v[104:107], v98, s[32:33] offset:1024
    global_load_dwordx4 v[108:111], v98, s[32:33] offset:2048
    s_cmp_eq_u32 s38, 0
    s_cbranch_scc1 KD_LX_hi
    global_load_dwordx4 v[124:127], v95, s[32:33] offset:0
    global_load_dwordx4 v[128:131], v95, s[32:33] offset:1024
    global_load_dwordx4 v[132:135], v95, s[32:33] offset:2048
KD_LX_hi:
    s_barrier
    s_branch KD_SEL2
KD_ROW:
    v_lshrrev_b32 v7, 5, v0
    v_and_b32 v4, 31, v0
    s_mul_i32 s4, s2, 10240
    v_lshlrev_b32 v5, 3, v4
    v_mul_u32_u24 v6, 1280, v7
    v_add_u32 v6, v6, v5
    v_add_u32 v8, s4, v6
    v_lshlrev_b32 v3, 6, v4
    v_lshl_add_u32 v3, v7, 3, v3
    s_add_u32 s5, s4, 4198400
    v_add_u32 v3, s5, v3
    v_add_u32 v9, 8192, v3
    s_waitcnt lgkmcnt(0)
    global_load_dwordx2 v[20:21], v3, s[32:33] offset:-4096
    global_load_dwordx2 v[32:33], v8, s[26:27] offset:0
    global_load_dwordx2 v[22:23], v3, s[32:33] offset:-2048
    global_load_dwordx2 v[34:35], v8, s[26:27] offset:256
    global_load_dwordx2 v[24:25], v3, s[32:33] offset:0
    global_load_dwordx2 v[36:37], v8, s[26:27] offset:512
    global_load_dwordx2 v[26:27], v3, s[32:33] offset:2048
    global_load_dwordx2 v[38:39], v8, s[26:27] offset:768
    global_load_dwordx2 v[28:29], v9, s[32:33] offset:-4096
    global_load_dwordx2 v[40:41], v8, s[26:27] offset:1024
    global_load_dwordx2 v[44:45], v5, s[28:29] offset:0
    global_load_dwordx2 v[46:47], v5, s[28:29] offset:256
    global_load_dwordx2 v[48:49], v5, s[28:29] offset:512
    global_load_dwordx2 v[50:51], v5, s[28:29] offset:768
    global_load_dwordx2 v[52:53], v5, s[28:29] offset:1024
    v_mov_b32 v12, 16256
    v_mov_b32 v13, 1065353216
    v_mov_b32 v14, 0x3f803f80
    v_mov_b32 v10, 0
    v_mov_b32 v11, 0
    v_mov_b32 v16, 0
    v_mov_b32 v17, 0
    v_add_u32 v9, 6815744, v8
    s_waitcnt vmcnt(5)
    s_cmp_eq_u32 s36, 1
    s_cbranch_scc1 KD_L2_lo
    global_load_dwordx4 v[100:103], v96, s[32:33] offset:0
    global_load_dwordx4 v[104:107], v96, s[32:33] offset:1024
    global_load_dwordx4 v[108:111], v96, s[32:33] offset:2048
    global_load_dwordx4 v[112:115], v96, s[32:33] offset:3072
    global_load_dwordx4 v[116:119], v97, s[32:33]
    s_branch KD_LX_lo
KD_L2_lo:
    global_load_dwordx4 v[100:103], v98, s[32:33] offset:0
    global_load_dwordx4 v[104:107], v98, s[32:33] offset:1024
    global_load_dwordx4 v[108:111], v98, s[32:33] offset:2048
    s_cmp_eq_u32 s38, 0
    s_cbranch_scc1 KD_LX_lo
    global_load_dwordx4 v[124:127], v95, s[32:33] offset:0
    global_load_dwordx4 v[128:131], v95, s[32:33] offset:1024
    global_load_dwordx4 v[132:135], v95, s[32:33] offset:2048
KD_LX_lo:
    v_lshlrev_b32 v68, 16, v20
    v_and_b32 v69, 0xffff0000, v20
    v_lshlrev_b32 v70, 16, v21
    v_and_b32 v71, 0xffff0000, v21
    v_lshlrev_b32 v72, 16, v22
    v_and_b32 v73, 0xffff0000, v22
    v_lshlrev_b32 v74, 16, v23
    v_and_b32 v75, 0xffff0000, v23
    v_lshlrev_b32 v76, 16, v24
    v_and_b32 v77, 0xffff0000, v24
    v_lshlrev_b32 v78, 16, v25
    v_and_b32 v79, 0xffff0000, v25
    v_lshlrev_b32 v80, 16, v26
    v_and_b32 v81, 0xffff0000, v26
    v_lshlrev_b32 v82, 16, v27
    v_and_b32 v83, 0xffff0000, v27
    v_lshlrev_b32 v84, 16, v28
    v_and_b32 v85, 0xffff0000, v28
    v_lshlrev_b32 v86, 16, v29
    v_and_b32 v87, 0xffff0000, v29
    v_dot2_f32_bf16 v68, v32, v12, v68
    v_dot2_f32_bf16 v69, v32, v13, v69
    v_dot2_f32_bf16 v70, v33, v12, v70
    v_dot2_f32_bf16 v71, v33, v13, v71
    v_dot2_f32_bf16 v72, v34, v12, v72
    v_dot2_f32_bf16 v73, v34, v13, v73
    v_dot2_f32_bf16 v74, v35, v12, v74
    v_dot2_f32_bf16 v75, v35, v13, v75
    v_dot2_f32_bf16 v76, v36, v12, v76
    v_dot2_f32_bf16 v77, v36, v13, v77
    v_dot2_f32_bf16 v78, v37, v12, v78
    v_dot2_f32_bf16 v79, v37, v13, v79
    v_dot2_f32_bf16 v80, v38, v12, v80
    v_dot2_f32_bf16 v81, v38, v13, v81
    v_dot2_f32_bf16 v82, v39, v12, v82
    v_dot2_f32_bf16 v83, v39, v13, v83
    v_dot2_f32_bf16 v84, v40, v12, v84
    v_dot2_f32_bf16 v85, v40, v13, v85
    v_dot2_f32_bf16 v86, v41, v12, v86
    v_dot2_f32_bf16 v87, v41, v13, v87
    v_cvt_pk_bf16_f32 v56, v68, v69
    v_cvt_pk_bf16_f32 v57, v70, v71
    v_cvt_pk_bf16_f32 v58, v72, v73
    v_cvt_pk_bf16_f32 v59, v74, v75
    v_cvt_pk_bf16_f32 v60, v76, v77
    v_cvt_pk_bf16_f32 v61, v78, v79
    v_cvt_pk_bf16_f32 v62, v80, v81
    v_cvt_pk_bf16_f32 v63, v82, v83
    v_cvt_pk_bf16_f32 v64, v84, v85
    v_cvt_pk_bf16_f32 v65, v86, v87
    v_dot2c_f32_bf16 v10, v56, v14
    v_dot2c_f32_bf16 v11, v56, v56
    v_dot2c_f32_bf16 v16, v57, v14
    v_dot2c_f32_bf16 v17, v57, v57
    v_dot2c_f32_bf16 v10, v58, v14
    v_dot2c_f32_bf16 v11, v58, v58
    v_dot2c_f32_bf16 v16, v59, v14
    v_dot2c_f32_bf16 v17, v59, v59
    v_dot2c_f32_bf16 v10, v60, v14
    v_dot2c_f32_bf16 v11, v60, v60
    v_dot2c_f32_bf16 v16, v61, v14
    v_dot2c_f32_bf16 v17, v61, v61
    v_dot2c_f32_bf16 v10, v62, v14
    v_dot2c_f32_bf16 v11, v62, v62
    v_dot2c_f32_bf16 v16, v63, v14
    v_dot2c_f32_bf16 v17, v63, v63
    v_dot2c_f32_bf16 v10, v64, v14
    v_dot2c_f32_bf16 v11, v64, v64
    v_dot2c_f32_bf16 v16, v65, v14
    v_dot2c_f32_bf16 v17, v65, v65
    s_nop 2
    v_add_f32 v10, v10, v16
    v_add_f32 v11, v11, v17
    s_nop 0
    v_add_f32_dpp v10, v10, v10 row_ror:8 row_mask:0xf bank_mask:0xf
    v_add_f32_dpp v11, v11, v11 row_ror:8 row_mask:0xf bank_mask:0xf
    s_nop 0
    v_add_f32_dpp v10, v10, v10 row_ror:4 row_mask:0xf bank_mask:0xf
    v_add_f32_dpp v11, v11, v11 row_ror:4 row_mask:0xf bank_mask:0xf
    s_nop 0
    v_add_f32_dpp v10, v10, v10 row_ror:2 row_mask:0xf bank_mask:0xf
    v_add_f32_dpp v11, v11, v11 row_ror:2 row_mask:0xf bank_mask:0xf
    s_nop 0
    v_add_f32_dpp v10, v10, v10 row_ror:1 row_mask:0xf bank_mask:0xf
    v_add_f32_dpp v11, v11, v11 row_ror:1 row_mask:0xf bank_mask:0xf
    v_mov_b32 v16, v10
    v_mov_b32 v17, v11
    s_nop 0
    v_permlane16_swap_b32 v10, v16
    v_permlane16_swap_b32 v11, v17
    v_add_f32 v10, v10, v16
    v_add_f32 v11, v11, v17
    v_mul_f32 v10, 986500301, v10
    v_mul_f32 v11, 986500301, v11
    v_fma_f32 v11, -v10, v10, v11
    v_max_f32 v11, 0, v11
    v_cvt_pk_bf16_f32 v15, v10, v11
    v_lshlrev_b32 v10, 16, v15
    v_and_b32 v11, 0xffff0000, v15
    v_add_f32 v11, 925353388, v11
    v_cvt_pk_bf16_f32 v11, v11, v11
    v_and_b32 v11, 0xffff0000, v11
    v_sqrt_f32 v11, v11
    s_nop 0
    v_cvt_pk_bf16_f32 v11, v11, v11
    v_and_b32 v11, 0xffff0000, v11
    v_rcp_f32 v11, v11
    v_sub_f32 v10, 0, v10
    v_dot2_f32_bf16 v68, v56, v12, v10
    v_dot2_f32_bf16 v69, v56, v13, v10
    v_dot2_f32_bf16 v70, v57, v12, v10
    v_dot2_f32_bf16 v71, v57, v13, v10
    v_dot2_f32_bf16 v72, v58, v12, v10
    v_dot2_f32_bf16 v73, v58, v13, v10
    v_dot2_f32_bf16 v74, v59, v12, v10
    v_dot2_f32_bf16 v75, v59, v13, v10
    v_dot2_f32_bf16 v76, v60, v12, v10
    v_dot2_f32_bf16 v77, v60, v13, v10
    v_dot2_f32_bf16 v78, v61, v12, v10
    v_dot2_f32_bf16 v79, v61, v13, v10
    v_dot2_f32_bf16 v80, v62, v12, v10
    v_dot2_f32_bf16 v81, v62, v13, v10
    v_dot2_f32_bf16 v82, v63, v12, v10
    v_dot2_f32_bf16 v83, v63, v13, v10
    v_dot2_f32_bf16 v84, v64, v12, v10
    v_dot2_f32_bf16 v85, v64, v13, v10
    v_dot2_f32_bf16 v86, v65, v12, v10
    v_dot2_f32_bf16 v87, v65, v13, v10
    v_cvt_pk_bf16_f32 v20, v68, v69
    v_cvt_pk_bf16_f32 v21, v70, v71
    v_cvt_pk_bf16_f32 v22, v72, v73
    v_cvt_pk_bf16_f32 v23, v74, v75
    v_cvt_pk_bf16_f32 v24, v76, v77
    v_cvt_pk_bf16_f32 v25, v78, v79
    v_cvt_pk_bf16_f32 v26, v80, v81
    v_cvt_pk_bf16_f32 v27, v82, v83
    v_cvt_pk_bf16_f32 v28, v84, v85
    v_cvt_pk_bf16_f32 v29, v86, v87
    v_lshlrev_b32 v68, 16, v20
    v_and_b32 v69, 0xffff0000, v20
    v_lshlrev_b32 v70, 16, v21
    v_and_b32 v71, 0xffff0000, v21
    v_lshlrev_b32 v72, 16, v22
    v_and_b32 v73, 0xffff0000, v22
    v_lshlrev_b32 v74, 16, v23
    v_and_b32 v75, 0xffff0000, v23
    v_lshlrev_b32 v76, 16, v24
    v_and_b32 v77, 0xffff0000, v24
    v_lshlrev_b32 v78, 16, v25
    v_and_b32 v79, 0xffff0000, v25
    v_lshlrev_b32 v80, 16, v26
    v_and_b32 v81, 0xffff0000, v26
    v_lshlrev_b32 v82, 16, v27
    v_and_b32 v83, 0xffff0000, v27
    v_lshlrev_b32 v84, 16, v28
    v_and_b32 v85, 0xffff0000, v28
    v_lshlrev_b32 v86, 16, v29
    v_and_b32 v87, 0xffff0000, v29
    v_mov_b32 v16, v11
    v_mov_b32 v17, v11
    v_pk_mul_f32 v[68:69], v[68:69], v[16:17]
    v_pk_mul_f32 v[70:71], v[70:71], v[16:17]
    v_pk_mul_f32 v[72:73], v[72:73], v[16:17]
    v_pk_mul_f32 v[74:75], v[74:75], v[16:17]
    v_pk_mul_f32 v[76:77], v[76:77], v[16:17]
    v_pk_mul_f32 v[78:79], v[78:79], v[16:17]
    v_pk_mul_f32 v[80:81], v[80:81], v[16:17]
    v_pk_mul_f32 v[82:83], v[82:83], v[16:17]
    v_pk_mul_f32 v[84:85], v[84:85], v[16:17]
    v_pk_mul_f32 v[86:87], v[86:87], v[16:17]
    v_cvt_pk_bf16_f32 v20, v68, v69
    v_cvt_pk_bf16_f32 v21, v70, v71
    v_cvt_pk_bf16_f32 v22, v72, v73
    v_cvt_pk_bf16_f32 v23, v74, v75
    v_cvt_pk_bf16_f32 v24, v76, v77
    v_cvt_pk_bf16_f32 v25, v78, v79
    v_cvt_pk_bf16_f32 v26, v80, v81
    v_cvt_pk_bf16_f32 v27, v82, v83
    v_cvt_pk_bf16_f32 v28, v84, v85
    v_cvt_pk_bf16_f32 v29, v86, v87
    global_store_dwordx2 v9, v[20:21], s[32:33] offset:0 sc1
    global_store_dwordx2 v9, v[22:23], s[32:33] offset:256 sc1
    global_store_dwordx2 v9, v[24:25], s[32:33] offset:512 sc1
    global_store_dwordx2 v9, v[26:27], s[32:33] offset:768 sc1
    global_store_dwordx2 v9, v[28:29], s[32:33] offset:1024 sc1
    v_mov_b32 v14, 0
    v_mov_b32 v15, 0
    v_lshlrev_b32 v68, 16, v20
    v_and_b32 v69, 0xffff0000, v20
    v_lshlrev_b32 v70, 16, v21
    v_and_b32 v71, 0xffff0000, v21
    v_lshlrev_b32 v72, 16, v22
    v_and_b32 v73, 0xffff0000, v22
    v_lshlrev_b32 v74, 16, v23
    v_and_b32 v75, 0xffff0000, v23
    v_lshlrev_b32 v76, 16, v24
    v_and_b32 v77, 0xffff0000, v24
    v_lshlrev_b32 v78, 16, v25
    v_and_b32 v79, 0xffff0000, v25
    v_lshlrev_b32 v80, 16, v26
    v_and_b32 v81, 0xffff0000, v26
    v_lshlrev_b32 v82, 16, v27
    v_and_b32 v83, 0xffff0000, v27
    v_lshlrev_b32 v84, 16, v28
    v_and_b32 v85, 0xffff0000, v28
    v_lshlrev_b32 v86, 16, v29
    v_and_b32 v87, 0xffff0000, v29
    v_dot2_f32_bf16 v68, v56, v12, v68
    v_dot2_f32_bf16 v69, v56, v13, v69
    v_dot2_f32_bf16 v70, v57, v12, v70
    v_dot2_f32_bf16 v71, v57, v13, v71
    v_dot2_f32_bf16 v72, v58, v12, v72
    v_dot2_f32_bf16 v73, v58, v13, v73
    v_dot2_f32_bf16 v74, v59, v12, v74
    v_dot2_f32_bf16 v75, v59, v13, v75
    v_dot2_f32_bf16 v76, v60, v12, v76
    v_dot2_f32_bf16 v77, v60, v13, v77
    v_dot2_f32_bf16 v78, v61, v12, v78
    v_dot2_f32_bf16 v79, v61, v13, v79
    v_dot2_f32_bf16 v80, v62, v12, v80
    v_dot2_f32_bf16 v81, v62, v13, v81
    v_dot2_f32_bf16 v82, v63, v12, v82
    v_dot2_f32_bf16 v83, v63, v13, v83
    v_dot2_f32_bf16 v84, v64, v12, v84
    v_dot2_f32_bf16 v85, v64, v13, v85
    v_dot2_f32_bf16 v86, v65, v12, v86
    v_dot2_f32_bf16 v87, v65, v13, v87
    v_cvt_pk_bf16_f32 v32, v68, v69
    v_cvt_pk_bf16_f32 v33, v70, v71
    v_cvt_pk_bf16_f32 v34, v72, v73
    v_cvt_pk_bf16_f32 v35, v74, v75
    v_cvt_pk_bf16_f32 v36, v76, v77
    v_cvt_pk_bf16_f32 v37, v78, v79
    v_cvt_pk_bf16_f32 v38, v80, v81
    v_cvt_pk_bf16_f32 v39, v82, v83
    v_cvt_pk_bf16_f32 v40, v84, v85
    v_cvt_pk_bf16_f32 v41, v86, v87
    global_store_dwordx2 v8, v[32:33], s[30:31] offset:0 sc1
    global_store_dwordx2 v8, v[34:35], s[30:31] offset:256 sc1
    global_store_dwordx2 v8, v[36:37], s[30:31] offset:512 sc1
    global_store_dwordx2 v8, v[38:39], s[30:31] offset:768 sc1
    global_store_dwordx2 v8, v[40:41], s[30:31] offset:1024 sc1
    s_waitcnt vmcnt(10)
    v_dot2c_f32_bf16 v14, v20, v44
    v_dot2c_f32_bf16 v15, v21, v45
    v_dot2c_f32_bf16 v14, v22, v46
    v_dot2c_f32_bf16 v15, v23, v47
    v_dot2c_f32_bf16 v14, v24, v48
    v_dot2c_f32_bf16 v15, v25, v49
    v_dot2c_f32_bf16 v14, v26, v50
    v_dot2c_f32_bf16 v15, v27, v51
    v_dot2c_f32_bf16 v14, v28, v52
    v_dot2c_f32_bf16 v15, v29, v53
    s_nop 2
    v_add_f32 v14, v14, v15
    s_nop 1
    v_add_f32_dpp v14, v14, v14 row_ror:8 row_mask:0xf bank_mask:0xf
    s_nop 1
    v_add_f32_dpp v14, v14, v14 row_ror:4 row_mask:0xf bank_mask:0xf
    s_nop 1
    v_add_f32_dpp v14, v14, v14 row_ror:2 row_mask:0xf bank_mask:0xf
    s_nop 1
    v_add_f32_dpp v14, v14, v14 row_ror:1 row_mask:0xf bank_mask:0xf
    v_mov_b32 v15, v14
    s_nop 1
    v_permlane16_swap_b32 v14, v15
    v_add_f32 v14, v14, v15
    v_cvt_pk_bf16_f32 v40, v14, v14
    v_and_b32 v40, 0xffff0000, v40
    v_ashrrev_i32 v41, 31, v40
    v_or_b32 v41, 0x80000000, v41
    v_xor_b32 v40, v40, v41
    v_and_b32 v40, 0xffff0000, v40
    s_lshl_b32 s6, s2, 3
    v_add_u32 v42, s6, v7
    v_sub_u32 v43, 2047, v42
    v_or_b32 v40, v40, v43
    v_lshlrev_b32 v42, 2, v7
    v_cmp_eq_u32 vcc, 0, v4
    s_nop 0
    s_mov_b64 exec, vcc
    ds_write_b32 v42, v40 offset:896
    s_mov_b64 exec, -1
    s_waitcnt vmcnt(0) lgkmcnt(0)
    s_barrier
    s_cmp_lg_u32 s3, 0
    s_cbranch_scc1 KD_KPUB
    v_lshlrev_b32 v42, 2, v2
    ds_read_b32 v40, v42 offset:896
    s_lshl_b32 s6, s2, 5
    s_add_u32 s6, s6, 9437184
    v_add_u32 v42, s6, v42
    s_waitcnt lgkmcnt(0)
    s_mov_b64 exec, 0xff
    global_store_dword v42, v40, s[32:33] sc1
    s_mov_b64 exec, -1
KD_KPUB:
    v_lshlrev_b32 v4, 5, v0
    v_add_u32 v4, 9437184, v4
    s_mov_b32 s12, 0
    v_mov_b32 v21, -1
    s_sleep 20
KD_KP:
    global_load_dwordx4 v[8:11], v4, s[32:33] sc1
    global_load_dwordx4 v[12:15], v4, s[32:33] offset:16 sc1
    s_waitcnt vmcnt(0)
    v_max3_u32 v16, v8, v9, v10
    v_max3_u32 v17, v11, v12, v13
    v_max3_u32 v16, v16, v14, v15
    v_max_u32 v16, v16, v17
    v_cmp_eq_u32 vcc, v21, v16
    s_nop 0
    s_cmp_eq_u64 vcc, 0
    s_cbranch_scc1 KD_KP_OK
    s_add_u32 s12, s12, 1
    s_cmp_ge_u32 s12, 65536
    s_cbranch_scc1 KD_KP_OK
    s_sleep 8
    s_branch KD_KP
KD_KP_OK:
    v_max_u32 v16, v8, v9
    v_min_u32 v9, v8, v9
    v_max_u32 v8, v10, v11
    v_min_u32 v11, v10, v11
    v_max_u32 v10, v12, v13
    v_min_u32 v13, v12, v13
    v_max_u32 v12, v14, v15
    v_min_u32 v15, v14, v15
    v_max_u32 v14, v16, v8
    v_min_u32 v8, v16, v8
    v_max_u32 v16, v9, v11
    v_min_u32 v11, v9, v11
    v_max_u32 v9, v10, v12
    v_min_u32 v12, v10, v12
    v_max_u32 v10, v13, v15
    v_min_u32 v15, v13, v15
    v_max_u32 v13, v16, v8
    v_min_u32 v8, v16, v8
    v_max_u32 v16, v10, v12
    v_min_u32 v12, v10, v12
    v_max_u32 v10, v14, v9
    v_min_u32 v9, v14, v9
    v_max_u32 v14, v11, v15
    v_min_u32 v15, v11, v15
    v_max_u32 v11, v13, v16
    v_min_u32 v16, v13, v16
    v_max_u32 v13, v8, v12
    v_min_u32 v12, v8, v12
    v_max_u32 v8, v11, v9
    v_min_u32 v9, v11, v9
    v_max_u32 v11, v14, v12
    v_min_u32 v12, v14, v12
    v_max_u32 v14, v13, v9
    v_min_u32 v9, v13, v9
    v_max_u32 v13, v11, v16
    v_min_u32 v16, v11, v16
    v_max_u32 v11, v13, v9
    v_min_u32 v9, v13, v9
    v_mov_b32 v17, v10
    v_mov_b32 v18, v8
    s_nop 0
    v_min_u32_dpp v19, v17, v17 row_shr:1 row_mask:0xf bank_mask:0xf bound_ctrl:0
    v_max_u32_dpp v17, v17, v17 row_shr:1 row_mask:0xf bank_mask:0xf bound_ctrl:0
    v_max_u32_dpp v20, v18, v18 row_shr:1 row_mask:0xf bank_mask:0xf bound_ctrl:0
    v_max_u32 v18, v19, v20
    v_min_u32_dpp v19, v17, v17 row_shr:2 row_mask:0xf bank_mask:0xf bound_ctrl:0
    v_max_u32_dpp v17, v17, v17 row_shr:2 row_mask:0xf bank_mask:0xf bound_ctrl:0
    v_max_u32_dpp v20, v18, v18 row_shr:2 row_mask:0xf bank_mask:0xf bound_ctrl:0
    v_max_u32 v18, v19, v20
    v_min_u32_dpp v19, v17, v17 row_shr:4 row_mask:0xf bank_mask:0xf bound_ctrl:0
    v_max_u32_dpp v17, v17, v17 row_shr:4 row_mask:0xf bank_mask:0xf bound_ctrl:0
    v_max_u32_dpp v20, v18, v18 row_shr:4 row_mask:0xf bank_mask:0xf bound_ctrl:0
    v_max_u32 v18, v19, v20
    v_min_u32_dpp v19, v17, v17 row_shr:8 row_mask:0xf bank_mask:0xf bound_ctrl:0
    v_max_u32_dpp v17, v17, v17 row_shr:8 row_mask:0xf bank_mask:0xf bound_ctrl:0
    v_max_u32_dpp v20, v18, v18 row_shr:8 row_mask:0xf bank_mask:0xf bound_ctrl:0
    v_max_u32 v18, v19, v20
    v_min_u32_dpp v19, v17, v17 row_bcast:15 row_mask:0xa bank_mask:0xf
    v_max_u32_dpp v17, v17, v17 row_bcast:15 row_mask:0xa bank_mask:0xf
    v_max_u32_dpp v20, v18, v18 row_bcast:15 row_mask:0xa bank_mask:0xf
    v_max_u32 v18, v19, v20
    v_min_u32_dpp v19, v17, v17 row_bcast:31 row_mask:0xc bank_mask:0xf
    v_max_u32_dpp v17, v17, v17 row_bcast:31 row_mask:0xc bank_mask:0xf
    v_max_u32_dpp v20, v18, v18 row_bcast:31 row_mask:0xc bank_mask:0xf
    v_max_u32 v18, v19, v20
    v_readlane_b32 s40, v17, 63
    v_readlane_b32 s41, v18, 63
    s_nop 0
    v_cmp_eq_u32 vcc, s40, v10
    s_nop 1
    v_cndmask_b32 v10, v10, v8, vcc
    v_cndmask_b32 v8, v8, v14, vcc
    v_cndmask_b32 v14, v14, v11, vcc
    v_cndmask_b32 v11, v11, v9, vcc
    v_cndmask_b32 v9, v9, v16, vcc
    v_cndmask_b32 v16, v16, v12, vcc
    v_cndmask_b32 v12, v12, v15, vcc
    v_cmp_eq_u32 vcc, s41, v10
    s_nop 1
    v_cndmask_b32 v10, v10, v8, vcc
    v_cndmask_b32 v8, v8, v14, vcc
    v_cndmask_b32 v14, v14, v11, vcc
    v_cndmask_b32 v11, v11, v9, vcc
    v_cndmask_b32 v9, v9, v16, vcc
    v_cndmask_b32 v16, v16, v12, vcc
    v_mov_b32 v17, v10
    v_mov_b32 v18, v8
    s_nop 0
    v_min_u32_dpp v19, v17, v17 row_shr:1 row_mask:0xf bank_mask:0xf bound_ctrl:0
    v_max_u32_dpp v17, v17, v17 row_shr:1 row_mask:0xf bank_mask:0xf bound_ctrl:0
    v_max_u32_dpp v20, v18, v18 row_shr:1 row_mask:0xf bank_mask:0xf bound_ctrl:0
    v_max_u32 v18, v19, v20
    v_min_u32_dpp v19, v17, v17 row_shr:2 row_mask:0xf bank_mask:0xf bound_ctrl:0
    v_max_u32_dpp v17, v17, v17 row_shr:2 row_mask:0xf bank_mask:0xf bound_ctrl:0
    v_max_u32_dpp v20, v18, v18 row_shr:2 row_mask:0xf bank_mask:0xf bound_ctrl:0
    v_max_u32 v18, v19, v20
    v_min_u32_dpp v19, v17, v17 row_shr:4 row_mask:0xf bank_mask:0xf bound_ctrl:0
    v_max_u32_dpp v17, v17, v17 row_shr:4 row_mask:0xf bank_mask:0xf bound_ctrl:0
    v_max_u32_dpp v20, v18, v18 row_shr:4 row_mask:0xf bank_mask:0xf bound_ctrl:0
    v_max_u32 v18, v19, v20
    v_min_u32_dpp v19, v17, v17 row_shr:8 row_mask:0xf bank_mask:0xf bound_ctrl:0
    v_max_u32_dpp v17, v17, v17 row_shr:8 row_mask:0xf bank_mask:0xf bound_ctrl:0
    v_max_u32_dpp v20, v18, v18 row_shr:8 row_mask:0xf bank_mask:0xf bound_ctrl:0
    v_max_u32 v18, v19, v20
    v_min_u32_dpp v19, v17, v17 row_bcast:15 row_mask:0xa bank_mask:0xf
    v_max_u32_dpp v17, v17, v17 row_bcast:15 row_mask:0xa bank_mask:0xf
    v_max_u32_dpp v20, v18, v18 row_bcast:15 row_mask:0xa bank_mask:0xf
    v_max_u32 v18, v19, v20
    v_min_u32_dpp v19, v17, v17 row_bcast:31 row_mask:0xc bank_mask:0xf
    v_max_u32_dpp v17, v17, v17 row_bcast:31 row_mask:0xc bank_mask:0xf
    v_max_u32_dpp v20, v18, v18 row_bcast:31 row_mask:0xc bank_mask:0xf
    v_max_u32 v18, v19, v20
    v_readlane_b32 s42, v17, 63
    v_readlane_b32 s43, v18, 63
    s_nop 0
    v_cmp_eq_u32 vcc, s42, v10
    s_nop 1
    v_cndmask_b32 v10, v10, v8, vcc
    v_cndmask_b32 v8, v8, v14, vcc
    v_cndmask_b32 v14, v14, v11, vcc
    v_cndmask_b32 v11, v11, v9, vcc
    v_cndmask_b32 v9, v9, v16, vcc
    v_cmp_eq_u32 vcc, s43, v10
    s_nop 1
    v_cndmask_b32 v10, v10, v8, vcc
    v_cndmask_b32 v8, v8, v14, vcc
    v_cndmask_b32 v14, v14, v11, vcc
    v_cndmask_b32 v11, v11, v9, vcc
    v_mov_b32 v17, v10
    v_mov_b32 v18, v8
    s_nop 0
    v_min_u32_dpp v19, v17, v17 row_shr:1 row_mask:0xf bank_mask:0xf bound_ctrl:0
    v_max_u32_dpp v17, v17, v17 row_shr:1 row_mask:0xf bank_mask:0xf bound_ctrl:0
    v_max_u32_dpp v20, v18, v18 row_shr:1 row_mask:0xf bank_mask:0xf bound_ctrl:0
    v_max_u32 v18, v19, v20
    v_min_u32_dpp v19, v17, v17 row_shr:2 row_mask:0xf bank_mask:0xf bound_ctrl:0
    v_max_u32_dpp v17, v17, v17 row_shr:2 row_mask:0xf bank_mask:0xf bound_ctrl:0
    v_max_u32_dpp v20, v18, v18 row_shr:2 row_mask:0xf bank_mask:0xf bound_ctrl:0
    v_max_u32 v18, v19, v20
    v_min_u32_dpp v19, v17, v17 row_shr:4 row_mask:0xf bank_mask:0xf bound_ctrl:0
    v_max_u32_dpp v17, v17, v17 row_shr:4 row_mask:0xf bank_mask:0xf bound_ctrl:0
    v_max_u32_dpp v20, v18, v18 row_shr:4 row_mask:0xf bank_mask:0xf bound_ctrl:0
    v_max_u32 v18, v19, v20
    v_min_u32_dpp v19, v17, v17 row_shr:8 row_mask:0xf bank_mask:0xf bound_ctrl:0
    v_max_u32_dpp v17, v17, v17 row_shr:8 row_mask:0xf bank_mask:0xf bound_ctrl:0
    v_max_u32_dpp v20, v18, v18 row_shr:8 row_mask:0xf bank_mask:0xf bound_ctrl:0
    v_max_u32 v18, v19, v20
    v_min_u32_dpp v19, v17, v17 row_bcast:15 row_mask:0xa bank_mask:0xf
    v_max_u32_dpp v17, v17, v17 row_bcast:15 row_mask:0xa bank_mask:0xf
    v_max_u32_dpp v20, v18, v18 row_bcast:15 row_mask:0xa bank_mask:0xf
    v_max_u32 v18, v19, v20
    v_min_u32_dpp v19, v17, v17 row_bcast:31 row_mask:0xc bank_mask:0xf
    v_max_u32_dpp v17, v17, v17 row_bcast:31 row_mask:0xc bank_mask:0xf
    v_max_u32_dpp v20, v18, v18 row_bcast:31 row_mask:0xc bank_mask:0xf
    v_max_u32 v18, v19, v20
    v_readlane_b32 s44, v17, 63
    v_readlane_b32 s45, v18, 63
    s_nop 0
    v_cmp_eq_u32 vcc, s44, v10
    s_nop 1
    v_cndmask_b32 v10, v10, v8, vcc
    v_cndmask_b32 v8, v8, v14, vcc
    v_cndmask_b32 v14, v14, v11, vcc
    v_cmp_eq_u32 vcc, s45, v10
    s_nop 1
    v_cndmask_b32 v10, v10, v8, vcc
    v_cndmask_b32 v8, v8, v14, vcc
    v_mov_b32 v17, v10
    v_mov_b32 v18, v8
    s_nop 0
    v_min_u32_dpp v19, v17, v17 row_shr:1 row_mask:0xf bank_mask:0xf bound_ctrl:0
    v_max_u32_dpp v17, v17, v17 row_shr:1 row_mask:0xf bank_mask:0xf bound_ctrl:0
    v_max_u32_dpp v20, v18, v18 row_shr:1 row_mask:0xf bank_mask:0xf bound_ctrl:0
    v_max_u32 v18, v19, v20
    v_min_u32_dpp v19, v17, v17 row_shr:2 row_mask:0xf bank_mask:0xf bound_ctrl:0
    v_max_u32_dpp v17, v17, v17 row_shr:2 row_mask:0xf bank_mask:0xf bound_ctrl:0
    v_max_u32_dpp v20, v18, v18 row_shr:2 row_mask:0xf bank_mask:0xf bound_ctrl:0
    v_max_u32 v18, v19, v20
    v_min_u32_dpp v19, v17, v17 row_shr:4 row_mask:0xf bank_mask:0xf bound_ctrl:0
    v_max_u32_dpp v17, v17, v17 row_shr:4 row_mask:0xf bank_mask:0xf bound_ctrl:0
    v_max_u32_dpp v20, v18, v18 row_shr:4 row_mask:0xf bank_mask:0xf bound_ctrl:0
    v_max_u32 v18, v19, v20
    v_min_u32_dpp v19, v17, v17 row_shr:8 row_mask:0xf bank_mask:0xf bound_ctrl:0
    v_max_u32_dpp v17, v17, v17 row_shr:8 row_mask:0xf bank_mask:0xf bound_ctrl:0
    v_max_u32_dpp v20, v18, v18 row_shr:8 row_mask:0xf bank_mask:0xf bound_ctrl:0
    v_max_u32 v18, v19, v20
    v_min_u32_dpp v19, v17, v17 row_bcast:15 row_mask:0xa bank_mask:0xf
    v_max_u32_dpp v17, v17, v17 row_bcast:15 row_mask:0xa bank_mask:0xf
    v_max_u32_dpp v20, v18, v18 row_bcast:15 row_mask:0xa bank_mask:0xf
    v_max_u32 v18, v19, v20
    v_min_u32_dpp v19, v17, v17 row_bcast:31 row_mask:0xc bank_mask:0xf
    v_max_u32_dpp v17, v17, v17 row_bcast:31 row_mask:0xc bank_mask:0xf
    v_max_u32_dpp v20, v18, v18 row_bcast:31 row_mask:0xc bank_mask:0xf
    v_max_u32 v18, v19, v20
    v_readlane_b32 s46, v17, 63
    v_readlane_b32 s47, v18, 63
    v_mov_b32 v16, s40
    v_writelane_b32 v16, s41, 1
    v_writelane_b32 v16, s42, 2
    v_writelane_b32 v16, s43, 3
    v_writelane_b32 v16, s44, 4
    v_writelane_b32 v16, s45, 5
    v_writelane_b32 v16, s46, 6
    v_writelane_b32 v16, s47, 7
    s_lshl_b32 s6, s3, 5
    v_lshlrev_b32 v17, 2, v2
    v_add_u32 v17, s6, v17
    v_cmp_gt_u32 vcc, 8, v2
    s_nop 0
    s_and_saveexec_b64 s[20:21], vcc
    ds_write_b32 v17, v16
    s_mov_b64 exec, s[20:21]
KD_SEL2:
    v_and_b32 v17, 31, v2
    v_lshlrev_b32 v17, 2, v17
    v_lshrrev_b32 v18, 5, v2
    v_lshlrev_b32 v18, 6, v18
    v_mov_b32 v19, 0
    v_mov_b32 v20, 0
    s_waitcnt lgkmcnt(0)
    s_barrier
    ds_read_b32 v16, v17
    ds_read_b128 v[60:63], v18 offset:0
    ds_read_b128 v[64:67], v18 offset:16
    ds_read_b128 v[68:71], v18 offset:32
    ds_read_b128 v[72:75], v18 offset:48
    s_waitcnt lgkmcnt(0)
    v_cmp_gt_u32 s[50:51], v60, v16
    v_cmp_gt_u32 s[52:53], v61, v16
    v_cmp_gt_u32 s[54:55], v62, v16
    v_cmp_gt_u32 s[56:57], v63, v16
    v_addc_co_u32 v19, vcc, 0, v19, s[50:51]
    v_addc_co_u32 v20, vcc, 0, v20, s[52:53]
    v_addc_co_u32 v19, vcc, 0, v19, s[54:55]
    v_addc_co_u32 v20, vcc, 0, v20, s[56:57]
    v_cmp_gt_u32 s[50:51], v64, v16
    v_cmp_gt_u32 s[52:53], v65, v16
    v_cmp_gt_u32 s[54:55], v66, v16
    v_cmp_gt_u32 s[56:57], v67, v16
    v_addc_co_u32 v19, vcc, 0, v19, s[50:51]
    v_addc_co_u32 v20, vcc, 0, v20, s[52:53]
    v_addc_co_u32 v19, vcc, 0, v19, s[54:55]
    v_addc_co_u32 v20, vcc, 0, v20, s[56:57]
    v_cmp_gt_u32 s[50:51], v68, v16
    v_cmp_gt_u32 s[52:53], v69, v16
    v_cmp_gt_u32 s[54:55], v70, v16
    v_cmp_gt_u32 s[56:57], v71, v16
    v_addc_co_u32 v19, vcc, 0, v19, s[50:51]
    v_addc_co_u32 v20, vcc, 0, v20, s[52:53]
    v_addc_co_u32 v19, vcc, 0, v19, s[54:55]
    v_addc_co_u32 v20, vcc, 0, v20, s[56:57]
    v_cmp_gt_u32 s[50:51], v72, v16
    v_cmp_gt_u32 s[52:53], v73, v16
    v_cmp_gt_u32 s[54:55], v74, v16
    v_cmp_gt_u32 s[56:57], v75, v16
    v_addc_co_u32 v19, vcc, 0, v19, s[50:51]
    v_addc_co_u32 v20, vcc, 0, v20, s[52:53]
    v_addc_co_u32 v19, vcc, 0, v19, s[54:55]
    v_addc_co_u32 v20, vcc, 0, v20, s[56:57]
    v_add_u32 v19, v19, v20
    v_mov_b32 v20, v19
    s_nop 1
    v_permlane32_swap_b32 v19, v20
    v_add_u32 v19, v19, v20
    v_cmp_gt_u32 vcc, 8, v19
    v_cmp_gt_u32 s[22:23], 32, v2
    s_nop 0
    s_and_b64 vcc, vcc, s[22:23]
    v_lshlrev_b32 v19, 2, v19
    s_lshl_b32 s6, s3, 6
    s_add_u32 s6, s6, 256
    v_add_u32 v19, s6, v19
    s_and_saveexec_b64 s[20:21], vcc
    ds_write_b32 v19, v16
    s_mov_b64 exec, s[20:21]
    s_cmp_eq_u32 s36, 1
    s_cbranch_scc1 KD_F2
    v_and_b32 v17, 7, v2
    v_lshlrev_b32 v17, 2, v17
    v_add_u32 v17, s6, v17
    ds_read_b32 v16, v17
    v_lshrrev_b32 v21, 4, v2
    v_lshlrev_b32 v21, 4, v21
    s_mul_i32 s6, s35, 320
    s_add_u32 s6, s6, 6815744
    v_add_u32 v21, s6, v21
    s_waitcnt lgkmcnt(0)
    v_and_b32 v18, 0x7ff, v16
    v_sub_u32 v18, 2047, v18
    v_mul_u32_u24 v20, 1280, v18
    v_add_u32 v20, v20, v21
    global_load_dwordx4 v[60:63], v20, s[32:33] offset:0 sc1
    global_load_dwordx4 v[64:67], v20, s[32:33] offset:64 sc1
    global_load_dwordx4 v[68:71], v20, s[32:33] offset:128 sc1
    global_load_dwordx4 v[72:75], v20, s[32:33] offset:192 sc1
    global_load_dwordx4 v[76:79], v20, s[32:33] offset:256 sc1
    v_mov_b32 v24, 0
    v_mov_b32 v25, 0
    v_mov_b32 v26, 0
    v_mov_b32 v27, 0
    v_lshlrev_b32 v28, 4, v2
    s_lshl_b32 s6, s3, 10
    v_add_u32 v29, s6, v28
    s_waitcnt vmcnt(4)
    v_mfma_f32_16x16x32_bf16 v[24:27], v[60:63], v[100:103], v[24:27]
    s_waitcnt vmcnt(3)
    v_mfma_f32_16x16x32_bf16 v[24:27], v[64:67], v[104:107], v[24:27]
    s_waitcnt vmcnt(2)
    v_mfma_f32_16x16x32_bf16 v[24:27], v[68:71], v[108:111], v[24:27]
    s_waitcnt vmcnt(1)
    v_mfma_f32_16x16x32_bf16 v[24:27], v[72:75], v[112:115], v[24:27]
    s_waitcnt vmcnt(0)
    v_mfma_f32_16x16x32_bf16 v[24:27], v[76:79], v[116:119], v[24:27]
    s_nop 7
    ds_write_b128 v29, v[24:27] offset:1024
    s_waitcnt lgkmcnt(0)
    s_barrier
    s_cmp_lg_u32 s35, 0
    s_cbranch_scc1 KD_DONE
    v_lshrrev_b32 v56, 3, v2
    v_and_b32 v57, 7, v2
    v_lshrrev_b32 v58, 2, v56
    v_lshlrev_b32 v58, 8, v58
    v_lshl_add_u32 v58, v57, 4, v58
    v_and_b32 v59, 3, v56
    v_lshl_add_u32 v58, v59, 2, v58
    s_lshl_b32 s6, s3, 10
    v_add_u32 v58, s6, v58
    ds_read_b32 v40, v58 offset:1024
    ds_read_b32 v44, v58 offset:1152
    ds_read_b32 v41, v58 offset:2048
    ds_read_b32 v45, v58 offset:2176
    ds_read_b32 v42, v58 offset:3072
    ds_read_b32 v46, v58 offset:3200
    ds_read_b32 v43, v58 offset:4096
    ds_read_b32 v47, v58 offset:4224
    v_lshlrev_b32 v59, 1, v2
    s_lshl_b32 s6, s37, 7
    s_add_u32 s6, s6, 9502720
    v_add_u32 v59, s6, v59
    s_waitcnt lgkmcnt(0)
    v_add_f32 v40, v40, v41
    v_add_f32 v42, v42, v43
    v_add_f32 v44, v44, v45
    v_add_f32 v46, v46, v47
    v_add_f32 v40, v40, v42
    v_add_f32 v44, v44, v46
    v_cvt_pk_bf16_f32 v41, v40, v44
    v_lshlrev_b32 v40, 16, v41
    v_and_b32 v44, 0xffff0000, v41
    v_mul_f32 v42, 0xbfb8aa3b, v40
    v_exp_f32 v42, v42
    s_nop 0
    v_add_f32 v42, 1.0, v42
    v_rcp_f32 v42, v42
    s_nop 0
    v_mul_f32 v40, v40, v42
    v_cvt_pk_bf16_f32 v40, v40, v40
    v_and_b32 v40, 0xffff0000, v40
    v_mul_f32 v40, v40, v44
    v_cvt_pk_bf16_f32 v40, v40, v40
    global_store_short v59, v40, s[32:33] sc1
KD_DONE:
    s_endpgm
KD_F2:
    v_mov_b32 v36, 0
    v_mov_b32 v32, 0
    v_mov_b32 v52, 0
    v_mov_b32 v37, 0
    v_mov_b32 v33, 0
    v_mov_b32 v53, 0
    v_mov_b32 v38, 0
    v_mov_b32 v34, 0
    v_mov_b32 v54, 0
    v_mov_b32 v39, 0
    v_mov_b32 v35, 0
    v_mov_b32 v55, 0
    s_add_u32 s39, s34, 64
    s_cmp_eq_u32 s3, 0
    s_cselect_b32 s39, s34, s39
    s_cselect_b32 s9, 1, 0
    s_cmp_eq_u32 s3, 1
    s_cselect_b32 s10, s38, 0
    s_or_b32 s9, s9, s10
    s_cmp_eq_u32 s9, 0
    s_cbranch_scc1 KD_F2SL
    v_lshrrev_b32 v17, 3, v2
    v_lshlrev_b32 v17, 2, v17
    v_add_u32 v17, s6, v17
    ds_read_b32 v8, v17
    v_and_b32 v16, 7, v2
    s_lshl_b32 s6, s39, 3
    v_add_u32 v16, s6, v16
    v_lshrrev_b32 v17, 2, v16
    v_lshlrev_b32 v17, 6, v17
    v_and_b32 v18, 3, v16
    v_lshl_add_u32 v17, v18, 1, v17
    v_add_u32 v17, 4194304, v17
    s_waitcnt lgkmcnt(0)
    v_and_b32 v40, 0x7ff, v8
    v_sub_u32 v40, 2047, v40
    v_mul_u32_u24 v36, 1280, v40
    v_lshl_add_u32 v36, v16, 1, v36
    v_add_u32 v18, 6815744, v36
    global_load_ushort v20, v18, s[32:33] sc1
    global_load_ushort v24, v36, s[26:27]
    v_lshrrev_b32 v18, 3, v40
    v_mul_u32_u24 v18, 10240, v18
    v_and_b32 v19, 7, v40
    v_lshl_add_u32 v18, v19, 3, v18
    v_add_u32 v18, v18, v17
    global_load_ushort v44, v18, s[32:33]
    v_and_b32 v12, 0xffff0000, v8
    v_ashrrev_i32 v48, 31, v12
    v_not_b32 v48, v48
    v_or_b32 v48, 0x80000000, v48
    v_xor_b32 v12, v12, v48
    v_and_b32 v12, 0xffff0000, v12
    v_mul_f32 v12, 0xbfb8aa3b, v12
    v_exp_f32 v12, v12
    s_nop 0
    v_add_f32 v12, 1.0, v12
    v_rcp_f32 v12, v12
    s_nop 0
    v_cvt_pk_bf16_f32 v12, v12, v12
    v_and_b32 v12, 0xffff0000, v12
    s_waitcnt vmcnt(0)
    v_lshlrev_b32 v24, 16, v24
    v_lshlrev_b32 v44, 16, v44
    v_lshlrev_b32 v20, 16, v20
    v_add_f32 v24, v24, v44
    v_cvt_pk_bf16_f32 v24, v24, v24
    v_and_b32 v24, 0xffff0000, v24
    s_sleep 16
    s_branch KD_F2B2
KD_F2SL:
    s_sleep 36
KD_F2B2:
    s_mov_b32 s12, 0
    v_mov_b32 v61, 0xffff
KD_POLL:
    global_load_dwordx4 v[112:115], v99, s[32:33] offset:0 sc1
    global_load_dwordx4 v[116:119], v99, s[32:33] offset:1024 sc1
    global_load_dwordx4 v[120:123], v99, s[32:33] offset:2048 sc1
    s_waitcnt vmcnt(0)
    v_pk_max_u16 v62, v112, v113
    v_pk_max_u16 v63, v114, v115
    v_pk_max_u16 v62, v62, v116
    v_pk_max_u16 v63, v63, v117
    v_pk_max_u16 v62, v62, v118
    v_pk_max_u16 v63, v63, v119
    v_pk_max_u16 v62, v62, v120
    v_pk_max_u16 v63, v63, v121
    v_pk_max_u16 v62, v62, v122
    v_pk_max_u16 v63, v63, v123
    v_pk_max_u16 v62, v62, v63
    v_lshrrev_b32 v63, 16, v62
    v_and_b32 v62, 0xffff, v62
    v_max_u32 v62, v62, v63
    v_cmp_eq_u32 vcc, v61, v62
    s_nop 0
    s_cmp_eq_u64 vcc, 0
    s_cbranch_scc1 KD_ACT
    s_add_u32 s12, s12, 1
    s_cmp_ge_u32 s12, 65536
    s_cbranch_scc1 KD_ACT
    s_sleep 6
    s_branch KD_POLL
KD_ACT:
    v_lshlrev_b32 v28, 4, v2
    s_lshl_b32 s6, s3, 10
    v_add_u32 v29, s6, v28
    v_mfma_f32_16x16x32_bf16 v[32:35], v[112:115], v[100:103], v[32:35]
    v_mfma_f32_16x16x32_bf16 v[32:35], v[116:119], v[104:107], v[32:35]
    v_mfma_f32_16x16x32_bf16 v[32:35], v[120:123], v[108:111], v[32:35]
    s_cmp_eq_u32 s38, 0
    s_cbranch_scc1 KD_NOB
    v_mfma_f32_16x16x32_bf16 v[52:55], v[112:115], v[124:127], v[52:55]
    v_mfma_f32_16x16x32_bf16 v[52:55], v[116:119], v[128:131], v[52:55]
    v_mfma_f32_16x16x32_bf16 v[52:55], v[120:123], v[132:135], v[52:55]
    s_nop 7
    v_mov_b32 v64, v52
    v_mov_b32 v65, v53
    v_mov_b32 v66, v54
    v_mov_b32 v67, v55
    v_permlane32_swap_b32 v52, v64
    v_permlane32_swap_b32 v53, v65
    v_permlane32_swap_b32 v54, v66
    v_permlane32_swap_b32 v55, v67
    v_add_f32_dpp v52, v64, v52 row_shl:8 row_mask:0xf bank_mask:0xf
    v_add_f32_dpp v53, v65, v53 row_shl:8 row_mask:0xf bank_mask:0xf
    v_add_f32_dpp v54, v66, v54 row_shl:8 row_mask:0xf bank_mask:0xf
    v_add_f32_dpp v55, v67, v55 row_shl:8 row_mask:0xf bank_mask:0xf
    ds_write_b128 v29, v[52:55] offset:9216
KD_NOB:
    s_nop 5
    v_mov_b32 v60, v32
    v_mov_b32 v61, v33
    v_mov_b32 v62, v34
    v_mov_b32 v63, v35
    v_permlane32_swap_b32 v32, v60
    v_permlane32_swap_b32 v33, v61
    v_permlane32_swap_b32 v34, v62
    v_permlane32_swap_b32 v35, v63
    v_add_f32_dpp v32, v60, v32 row_shl:8 row_mask:0xf bank_mask:0xf
    v_add_f32_dpp v33, v61, v33 row_shl:8 row_mask:0xf bank_mask:0xf
    v_add_f32_dpp v34, v62, v34 row_shl:8 row_mask:0xf bank_mask:0xf
    v_add_f32_dpp v35, v63, v35 row_shl:8 row_mask:0xf bank_mask:0xf
    ds_write_b128 v29, v[32:35] offset:1024
    s_waitcnt lgkmcnt(0)
    s_barrier
    s_cmp_eq_u32 s9, 0
    s_cbranch_scc1 KD_DONE2
    v_lshrrev_b32 v56, 3, v2
    v_and_b32 v57, 7, v2
    v_lshrrev_b32 v58, 2, v56
    v_lshlrev_b32 v58, 8, v58
    v_lshl_add_u32 v58, v57, 4, v58
    v_and_b32 v59, 3, v56
    v_lshl_add_u32 v58, v59, 2, v58
    s_lshl_b32 s6, s3, 13
    v_add_u32 v58, s6, v58
    ds_read_b32 v40, v58 offset:1024
    ds_read_b32 v41, v58 offset:2048
    ds_read_b32 v42, v58 offset:3072
    ds_read_b32 v43, v58 offset:4096
    ds_read_b32 v44, v58 offset:5120
    ds_read_b32 v45, v58 offset:6144
    ds_read_b32 v46, v58 offset:7168
    ds_read_b32 v47, v58 offset:8192
    s_waitcnt lgkmcnt(0)
    v_add_f32 v40, v40, v44
    v_add_f32 v41, v41, v45
    v_add_f32 v42, v42, v46
    v_add_f32 v43, v43, v47
    v_add_f32 v40, v40, v42
    v_add_f32 v41, v41, v43
    v_add_f32 v40, v40, v41
    v_cvt_pk_bf16_f32 v40, v40, v40
    v_and_b32 v40, 0xffff0000, v40
    v_mul_f32 v40, v40, v12
    v_cvt_pk_bf16_f32 v40, v40, v40
    v_and_b32 v40, 0xffff0000, v40
    v_add_f32 v40, v40, v20
    v_cvt_pk_bf16_f32 v40, v40, v40
    v_and_b32 v40, 0xffff0000, v40
    v_add_f32 v40, v40, v24
    v_cvt_pk_bf16_f32 v40, v40, v40
    global_store_short v36, v40, s[30:31] sc1
KD_DONE2:
    s_endpgm
KD_END:
    s_endpgm
.section .rodata,"a"
.p2align 6
.amdhsa_kernel ka_kernel
  .amdhsa_next_free_vgpr 128
  .amdhsa_next_free_sgpr 102
  .amdhsa_accum_offset 128
  .amdhsa_group_segment_fixed_size 0
  .amdhsa_kernarg_size 120
  .amdhsa_user_sgpr_count 2
  .amdhsa_user_sgpr_kernarg_segment_ptr 1
  .amdhsa_system_sgpr_workgroup_id_x 1
.end_amdhsa_kernel
.p2align 6
.amdhsa_kernel kd_kernel
  .amdhsa_next_free_vgpr 136
  .amdhsa_next_free_sgpr 102
  .amdhsa_accum_offset 136
  .amdhsa_group_segment_fixed_size 0
  .amdhsa_kernarg_size 120
  .amdhsa_user_sgpr_count 2
  .amdhsa_user_sgpr_kernarg_segment_ptr 1
  .amdhsa_system_sgpr_workgroup_id_x 1
.end_amdhsa_kernel
```
